```python
import torch

def _softmax(x, axis=-1):
    return torch.softmax(x, dim=axis)
def _gelu(x):
    return torch.nn.functional.gelu(x, approximate="tanh")
def _silu(x):
    return torch.nn.functional.silu(x)
def _sigmoid(x):
    return torch.sigmoid(x)
def _layernorm(x, axis=-1, eps=1e-5):
    m = x.mean(dim=axis, keepdim=True)
    v = x.var(dim=axis, keepdim=True, unbiased=False)
    return (x - m) / torch.sqrt(v + eps)
def _scatter_add(tgt, idx, src, axis=0):
    return tgt.clone().index_add_(axis, idx, src)
def _segment_sum(src, seg, n):
    out = torch.zeros((n,) + src.shape[1:], dtype=src.dtype)
    return out.index_add_(0, seg, src)
def _pad(x, pw):
    flat = tuple(v for pair in reversed(pw) for v in pair)
    return torch.nn.functional.pad(x, flat)

kernel_name = 'sequential_preLN__softmax_full_mha__mixer_channel_mlp__prompt'

def setup_inputs():

    _w = (lambda a: (lambda t: t.to(torch.bfloat16) if t.is_floating_point() else t)(torch.as_tensor(a)))
    def _A_setup():
        B, S, D = 1, 2048, 448
        return {
            "x": _w((lambda *s: torch.randn(*s, dtype=torch.bfloat16) * 0.05)(B, S, D)),
            "wqkv": _w((lambda *s: torch.randn(*s, dtype=torch.bfloat16) * 0.05)(D, 3 * D)),
            "wo": _w((lambda *s: torch.randn(*s, dtype=torch.bfloat16) * 0.05)(D, D)),
        }
    _A_in = _A_setup()

    def _B_setup():
        B, S, D, F = 1, 2048, 448, 1792
        return {
            "x": _w((lambda *s: torch.randn(*s, dtype=torch.bfloat16) * 0.05)(B, S, D)),
            "w1": _w((lambda *s: torch.randn(*s, dtype=torch.bfloat16) * 1.6)(D, F) * (D ** -0.5)),
            "b1": _w((lambda *s: torch.randn(*s, dtype=torch.bfloat16) * 0.8)(F)),
            "w2": _w((lambda *s: torch.randn(*s, dtype=torch.bfloat16) * 0.05)(F, D) * (F ** -0.5)),
            "b2": _w((lambda *s: torch.randn(*s, dtype=torch.bfloat16) * 0.05)(D)),
        }
    _B_in = _B_setup()

    return {
        "A_x": _A_in["x"],
        "A_wqkv": _A_in["wqkv"],
        "A_wo": _A_in["wo"],
        "B_x": _B_in["x"],
        "B_w1": _B_in["w1"],
        "B_b1": _B_in["b1"],
        "B_w2": _B_in["w2"],
        "B_b2": _B_in["b2"],
    }

def reference(A_x, A_wqkv, A_wo, B_x, B_w1, B_b1, B_w2, B_b2):
    def _A_ref(x, wqkv, wo):
        B, S, D = x.shape
        H = 16; Dh = D // H
        qkv = (lambda x, *d: x.permute(*d))((x @ wqkv).reshape(B, S, 3, H, Dh), 2, 0, 3, 1, 4)
        q, k, v = qkv[0], qkv[1], qkv[2]
        scale = Dh ** -0.5
        scores = torch.einsum("bhqd,bhkd->bhqk", q, k) * scale
        p = _softmax(scores, axis=-1)
        o = torch.einsum("bhqk,bhkd->bhqd", p, v)
        return (lambda x, *d: x.permute(*d))(o, 0, 2, 1, 3).reshape(B, S, D) @ wo

    def _B_ref(x, w1, b1, w2, b2):
        y = _layernorm(x, axis=-1)
        h = _gelu(torch.einsum("bsd,df->bsf", y, w1) + b1)
        return torch.einsum("bsf,fd->bsd", h, w2) + b2

    x = A_x
    h = x + _A_ref(_layernorm(x, axis=-1), A_wqkv, A_wo)
    h2 = h + _B_ref(_layernorm(h, axis=-1), B_w1, B_b1, B_w2, B_b2)
    return h2
```

```asm
; @launch grid=(256,1,1) block=(256,1,1) lds=163840
.amdgcn_target "amdgcn-amd-amdhsa--gfx950"
.text
.globl sequential_preLN__softmax_full_mha__mixer_channel_mlp__prompt_kernel
.p2align 8
.type sequential_preLN__softmax_full_mha__mixer_channel_mlp__prompt_kernel,@function
sequential_preLN__softmax_full_mha__mixer_channel_mlp__prompt_kernel:
    s_cmp_ge_u32 s2, 256
    s_cbranch_scc1 L_end
    s_load_dwordx8 s[64:71], s[0:1], 0
    s_load_dwordx8 s[40:47], s[0:1], 32
    s_load_dwordx4 s[4:7], s[0:1], 64
    s_load_dwordx2 s[72:73], s[0:1], 80
    s_getpc_b64 s[76:77]
L_pc:
    s_lshr_b32 s78, s2, 3
    s_lshl_b32 s78, s78, 11
    v_lshl_add_u32 v238, v0, 3, s78
    v_min_u32 v238, L_end-L_pc-8, v238
    v_add_co_u32 v238, vcc, s76, v238
    v_mov_b32 v239, s77
    s_nop 0
    v_addc_co_u32 v239, vcc, 0, v239, vcc
    global_load_dwordx2 v[238:239], v[238:239], off
    v_and_b32 v1, 63, v0
    v_lshrrev_b32 v2, 6, v0
    s_nop 0
    v_readfirstlane_b32 s3, v2
    v_lshlrev_b32 v2, 4, v1
    s_and_b32 s58, s2, 7
    s_lshr_b32 s59, s2, 3
    s_min_u32 s61, s59, 27
    s_mul_i32 s60, s61, 37
    s_lshr_b32 s60, s60, 8
    s_mul_i32 s62, s60, 7
    s_sub_u32 s51, s61, s62
    s_lshl_b32 s50, s58, 2
    s_add_u32 s50, s50, s60
    s_lshr_b32 s52, s50, 1
    s_lshr_b32 s60, s60, 1
    s_mul_i32 s60, s60, 14
    s_sub_u32 s53, s61, s60
    s_lshr_b32 s48, s59, 4
    s_lshl_b32 s60, s58, 1
    s_add_u32 s48, s48, s60
    s_and_b32 s49, s59, 15
    s_add_u32 s75, s58, s49
    s_mul_i32 s60, s75, 37
    s_lshr_b32 s60, s60, 8
    s_mul_i32 s60, s60, 7
    s_sub_u32 s75, s75, s60
    v_lshrrev_b32 v160, 3, v1
    v_mul_u32_u24 v160, 896, v160
    v_and_b32 v161, 7, v1
    v_lshrrev_b32 v162, 4, v1
    v_xor_b32_e64 v161, v161, v162
    v_lshl_add_u32 v45, v161, 4, v160
    v_xor_b32_e64 v161, 4, v161
    v_lshl_add_u32 v46, v161, 4, v160
    v_lshrrev_b32_e64 v160, 2, v1
    v_mul_u32_u24 v160, 2688, v160
    v_and_b32_e64 v161, 3, v1
    v_lshl_add_u32 v47, v161, 4, v160
    s_lshl_b32 s56, s49, 2
    s_add_u32 s56, s56, s3
    s_mul_i32 s60, s56, 28672
    s_mul_i32 s61, s3, 43008
    s_mul_i32 s57, s48, 56
    s_add_u32 s61, s61, s57
    s_lshl_b32 s62, s3, 12
    s_lshl_b32 s63, s3, 10
    s_add_u32 s63, s63, 16384
    s_waitcnt lgkmcnt(0)
    s_mov_b32 s8, s64
    s_and_b32 s9, s65, 0xffff
    s_mov_b32 s10, 1835008
    s_mov_b32 s11, 0x20000
    s_mov_b32 s12, s66
    s_and_b32 s13, s67, 0xffff
    s_mov_b32 s14, 1204224
    s_mov_b32 s15, 0x20000
    s_lshl_b32 s54, s75, 7
    s_add_u32 s54, s54, s60
    s_mul_i32 s55, s75, 172032
    s_add_u32 s55, s55, s61
    s_add_u32 s75, s75, 1
    s_cmp_eq_u32 s75, 7
    s_cselect_b32 s75, 0, s75
    s_add_u32 m0, s62, 0
    s_add_u32 s56, s54, 0
    buffer_load_dwordx4 v45, s[8:11], s56 offen lds
    s_add_u32 m0, s62, 1024
    s_add_u32 s56, s54, 7168
    buffer_load_dwordx4 v46, s[8:11], s56 offen lds
    s_add_u32 m0, s62, 2048
    s_add_u32 s56, s54, 14336
    buffer_load_dwordx4 v45, s[8:11], s56 offen lds
    s_add_u32 m0, s62, 3072
    s_add_u32 s56, s54, 21504
    buffer_load_dwordx4 v46, s[8:11], s56 offen lds
    s_add_u32 m0, s63, 0
    s_add_u32 s56, s55, 0
    buffer_load_dwordx4 v47, s[12:15], s56 offen lds
    s_add_u32 m0, s63, 4096
    s_add_u32 s56, s55, 896
    buffer_load_dwordx4 v47, s[12:15], s56 offen lds
    s_add_u32 m0, s63, 8192
    s_add_u32 s56, s55, 1792
    buffer_load_dwordx4 v47, s[12:15], s56 offen lds
    s_mov_b32 s16, s68
    s_and_b32 s17, s69, 0xffff
    s_mov_b32 s18, 401408
    s_mov_b32 s19, 0x20000
    s_mov_b32 s20, s40
    s_and_b32 s21, s41, 0xffff
    s_mov_b32 s22, 1605632
    s_mov_b32 s23, 0x20000
    s_mov_b32 s24, s44
    s_and_b32 s25, s45, 0xffff
    s_mov_b32 s26, 1605632
    s_mov_b32 s27, 0x20000
    s_mov_b32 s64, s42
    s_mov_b32 s65, s43
    s_mov_b32 s66, s46
    s_mov_b32 s67, s47
    s_mov_b32 s40, s64
    s_and_b32 s41, s65, 0xffff
    s_mov_b32 s42, 3584
    s_mov_b32 s43, 0x20000
    s_mov_b32 s44, s66
    s_and_b32 s45, s67, 0xffff
    s_mov_b32 s46, 896
    s_mov_b32 s47, 0x20000
    s_mov_b32 s32, s4
    s_and_b32 s33, s5, 0xffff
    s_mov_b32 s34, 1835008
    s_mov_b32 s35, 0x20000
    s_mov_b32 s36, s6
    s_and_b32 s37, s7, 0xffff
    s_mov_b32 s38, 256
    s_mov_b32 s39, 0x20000
    s_mov_b32 s28, s72
    s_and_b32 s29, s73, 0xffff
    s_mov_b32 s30, 27262976
    s_mov_b32 s31, 0x20000
    s_mov_b32 s68, 0x3f803f80
    s_or_b32 s4, s2, s3
    s_cmp_lg_u32 s4, 0
    s_cselect_b32 s6, 0, 1
    s_memrealtime s[4:5]
    s_waitcnt lgkmcnt(0)
    s_or_b32 s4, s4, 1
    v_mov_b32 v236, s4
    v_mov_b32_e64 v237, s5
    s_cmp_eq_u32 s6, 1
    s_cselect_b32 s6, 0, 0x1000
    v_mov_b32 v235, s6
    v_and_b32 v160, 31, v1
    v_lshrrev_b32 v161, 5, v1
    v_lshrrev_b32 v162, 1, v160
    v_and_b32 v162, 7, v162
    v_xor_b32 v162, v162, v161
    v_lshlrev_b32 v163, 7, v160
    v_add_u32 v163, s62, v163
    v_bfe_u32 v164, v1, 2, 2
    v_lshl_add_u32 v164, v161, 3, v164
    v_lshlrev_b32_e64 v164, 6, v164
    v_bfe_u32 v165, v1, 4, 1
    v_lshl_add_u32 v164, v165, 5, v164
    v_and_b32_e64 v165, 3, v1
    v_lshl_add_u32 v164, v165, 3, v164
    s_add_u32 s58, s3, 0
    s_and_b32 s58, s58, 3
    s_lshl_b32 s57, s58, 1
    v_xor_b32 v165, s57, v162
    v_lshl_add_u32 v16, v165, 4, v163
    s_lshl_b32 s57, s58, 10
    s_add_u32 s57, s57, 16384
    v_add_u32 v20, s57, v164
    s_add_u32 s58, s3, 1
    s_and_b32 s58, s58, 3
    s_lshl_b32 s57, s58, 1
    v_xor_b32 v165, s57, v162
    v_lshl_add_u32 v17, v165, 4, v163
    s_lshl_b32 s57, s58, 10
    s_add_u32 s57, s57, 16384
    v_add_u32 v21, s57, v164
    s_add_u32 s58, s3, 2
    s_and_b32 s58, s58, 3
    s_lshl_b32 s57, s58, 1
    v_xor_b32 v165, s57, v162
    v_lshl_add_u32 v18, v165, 4, v163
    s_lshl_b32 s57, s58, 10
    s_add_u32 s57, s57, 16384
    v_add_u32 v22, s57, v164
    s_add_u32 s58, s3, 3
    s_and_b32 s58, s58, 3
    s_lshl_b32 s57, s58, 1
    v_xor_b32 v165, s57, v162
    v_lshl_add_u32 v19, v165, 4, v163
    s_lshl_b32 s57, s58, 10
    s_add_u32 s57, s57, 16384
    v_add_u32 v23, s57, v164
    v_add_u32 v24, 57344, v16
    v_add_u32 v25, 57344, v17
    v_add_u32 v26, 57344, v18
    v_add_u32 v27, 57344, v19
    v_add_u32 v28, 57344, v20
    v_add_u32 v29, 57344, v21
    v_add_u32 v30, 57344, v22
    v_add_u32 v31, 57344, v23
    v_add_u32 v32, 114688, v16
    v_add_u32 v33, 114688, v17
    v_add_u32 v34, 114688, v18
    v_add_u32 v35, 114688, v19
    v_add_u32 v36, 114688, v20
    v_add_u32 v37, 114688, v21
    v_add_u32 v38, 114688, v22
    v_add_u32 v39, 114688, v23
    v_mov_b32 v152, 0
    v_mov_b32 v153, 0
    v_mov_b32 v154, 0
    v_mov_b32 v155, 0
    v_mov_b32 v156, 0
    v_mov_b32 v157, 0
    v_mov_b32 v158, 0
    v_mov_b32 v180, v160
    v_mov_b32 v181, v161
    s_lshl_b32 s57, s3, 3
    s_add_u32 s57, s57, 143360
    v_lshlrev_b32_e64 v184, 5, v180
    v_lshl_add_u32 v182, v181, 2, v184
    v_add_u32_e64 v182, s57, v182
    v_add_u32 v184, 143360, v184
    s_lshl_b32 s57, s3, 8
    s_add_u32 s57, s57, 146432
    v_lshl_add_u32 v183, v1, 2, s57
    v_lshl_add_u32 v185, v181, 4, s57
    v_cmp_eq_u32 vcc, 28, v180
    v_mov_b32 v186, s68
    v_mov_b32_e64 v187, 0
    v_cndmask_b32 v186, 0, v186, vcc
    v_mov_b32 v188, 0x3f80
    v_mov_b32 v41, 0x1000000
    s_lshl_b32 s81, s48, 6
    s_lshl_b32 s82, s3, 4
    s_add_u32 s81, s81, s82
    s_add_u32 s81, s81, s49
    s_lshl_b32 s81, s81, 7
    s_mov_b32 s76, s81
    v_mov_b32 v166, 0
    v_mov_b32 v167, 0
    v_mov_b32 v170, 0
    v_mov_b32 v171, 0
    v_mov_b32 v174, 0
    v_mov_b32 v175, 0
    v_mov_b32 v178, 0
    v_mov_b32 v179, 0
    s_lshl_b32 s54, s75, 7
    s_add_u32 s54, s54, s60
    s_mul_i32 s55, s75, 172032
    s_add_u32 s55, s55, s61
    s_add_u32 s75, s75, 1
    s_cmp_eq_u32 s75, 7
    s_cselect_b32 s75, 0, s75
    s_add_u32 m0, s62, 28672
    s_add_u32 s56, s54, 0
    buffer_load_dwordx4 v45, s[8:11], s56 offen lds
    s_add_u32 m0, s62, 29696
    s_add_u32 s56, s54, 7168
    buffer_load_dwordx4 v46, s[8:11], s56 offen lds
    s_add_u32 m0, s62, 30720
    s_add_u32 s56, s54, 14336
    buffer_load_dwordx4 v45, s[8:11], s56 offen lds
    s_add_u32 m0, s62, 31744
    s_add_u32 s56, s54, 21504
    buffer_load_dwordx4 v46, s[8:11], s56 offen lds
    s_add_u32 m0, s63, 28672
    s_add_u32 s56, s55, 0
    buffer_load_dwordx4 v47, s[12:15], s56 offen lds
    s_add_u32 m0, s63, 32768
    s_add_u32 s56, s55, 896
    buffer_load_dwordx4 v47, s[12:15], s56 offen lds
    s_add_u32 m0, s63, 36864
    s_add_u32 s56, s55, 1792
    buffer_load_dwordx4 v47, s[12:15], s56 offen lds
    s_mov_b64 exec, 1
    buffer_store_dwordx2 v[236:237], v235, s[36:39], 0 offen sc1
    s_mov_b64 exec, -1
    s_mov_b64 exec, 1
    buffer_load_dword v42, v41, s[28:31], s81 offen sc1
    s_lshl_b32 s81, s50, 1
    s_lshr_b32 s82, s3, 1
    s_add_u32 s81, s81, s82
    s_lshl_b32 s81, s81, 4
    s_lshl_b32 s82, s51, 1
    s_add_u32 s81, s81, s82
    s_and_b32 s82, s3, 1
    s_add_u32 s81, s81, s82
    s_lshl_b32 s81, s81, 7
    s_add_u32 s81, s81, 262144
    buffer_load_dword v43, v41, s[28:31], s81 offen sc1
    s_lshl_b32 s81, s52, 2
    s_add_u32 s81, s81, s3
    s_lshl_b32 s81, s81, 4
    s_add_u32 s81, s81, s53
    s_lshl_b32 s81, s81, 7
    s_add_u32 s81, s81, 393216
    buffer_load_dword v44, v41, s[28:31], s81 offen sc1
    s_mov_b64 exec, -1
    s_waitcnt vmcnt(11)
    s_barrier
    ds_read_b128 v[96:99], v16 offset:0
    ds_read_b64_tr_b16 v[128:129], v20 offset:0
    ds_read_b64_tr_b16 v[130:131], v20 offset:256
    ds_read_b64_tr_b16 v[132:133], v20 offset:4096
    ds_read_b64_tr_b16 v[134:135], v20 offset:4352
    ds_read_b64_tr_b16 v[136:137], v20 offset:8192
    ds_read_b64_tr_b16 v[138:139], v20 offset:8448
    ds_read_b128 v[100:103], v17 offset:0
    ds_read_b128 v[104:107], v18 offset:0
    ds_read_b128 v[108:111], v19 offset:0
    s_waitcnt lgkmcnt(3)
    v_mfma_f32_32x32x16_bf16 v[48:63], v[128:131], v[96:99], 0
    ds_read_b64_tr_b16 v[140:141], v21 offset:0
    ds_read_b64_tr_b16 v[142:143], v21 offset:256
    ds_read_b64_tr_b16 v[144:145], v21 offset:4096
    ds_read_b64_tr_b16 v[146:147], v21 offset:4352
    ds_read_b64_tr_b16 v[148:149], v21 offset:8192
    ds_read_b64_tr_b16 v[150:151], v21 offset:8448
    v_mfma_f32_32x32x16_bf16 v[64:79], v[132:135], v[96:99], 0
    s_lshl_b32 s54, s75, 7
    s_add_u32 s54, s54, s60
    s_mul_i32 s55, s75, 172032
    s_add_u32 s55, s55, s61
    s_add_u32 s75, s75, 1
    s_cmp_eq_u32 s75, 7
    s_cselect_b32 s75, 0, s75
    s_add_u32 m0, s62, 57344
    s_add_u32 s56, s54, 0
    buffer_load_dwordx4 v45, s[8:11], s56 offen lds
    v_lshrrev_b32_e64 v192, 3, v1
    v_bfe_u32 v193, v1, 4, 1
    v_lshlrev_b32 v194, 2, v193
    v_and_b32 v195, 7, v1
    v_mfma_f32_32x32x16_bf16 v[80:95], v[96:99], v[136:139], 0
    s_add_u32 m0, s62, 58368
    s_add_u32 s56, s54, 7168
    buffer_load_dwordx4 v46, s[8:11], s56 offen lds
    v_xor_b32 v194, v194, v195
    v_lshlrev_b32 v194, 4, v194
    v_mul_u32_u24 v4, 896, v192
    v_add_u32_e64 v4, v4, v194
    s_waitcnt lgkmcnt(6)
    v_dot2c_f32_bf16 v156, s68, v128
    v_dot2c_f32_bf16 v157, s68, v132
    v_dot2c_f32_bf16 v158, s68, v136
    v_dot2c_f32_bf16 v156, s68, v129
    v_dot2c_f32_bf16 v157, s68, v133
    v_dot2c_f32_bf16 v158, s68, v137
    v_dot2c_f32_bf16 v156, s68, v130
    v_dot2c_f32_bf16 v157, s68, v134
    v_dot2c_f32_bf16 v158, s68, v138
    v_dot2c_f32_bf16 v156, s68, v131
    v_dot2c_f32_bf16 v157, s68, v135
    v_dot2c_f32_bf16 v158, s68, v139
    v_dot2c_f32_bf16 v152, s68, v96
    v_dot2c_f32_bf16 v154, v96, v96
    v_dot2c_f32_bf16 v153, s68, v97
    v_dot2c_f32_bf16 v155, v97, v97
    v_dot2c_f32_bf16 v152, s68, v98
    v_dot2c_f32_bf16 v154, v98, v98
    v_dot2c_f32_bf16 v153, s68, v99
    v_dot2c_f32_bf16 v155, v99, v99
    v_dot2c_f32_bf16 v152, s68, v100
    v_dot2c_f32_bf16 v154, v100, v100
    v_dot2c_f32_bf16 v153, s68, v101
    v_dot2c_f32_bf16 v155, v101, v101
    v_dot2c_f32_bf16 v152, s68, v102
    v_dot2c_f32_bf16 v154, v102, v102
    v_dot2c_f32_bf16 v153, s68, v103
    v_dot2c_f32_bf16 v155, v103, v103
    v_dot2c_f32_bf16 v152, s68, v104
    v_dot2c_f32_bf16 v154, v104, v104
    v_dot2c_f32_bf16 v153, s68, v105
    v_dot2c_f32_bf16 v155, v105, v105
    v_dot2c_f32_bf16 v152, s68, v106
    v_dot2c_f32_bf16 v154, v106, v106
    v_dot2c_f32_bf16 v153, s68, v107
    v_dot2c_f32_bf16 v155, v107, v107
    v_dot2c_f32_bf16 v152, s68, v108
    v_dot2c_f32_bf16 v154, v108, v108
    v_dot2c_f32_bf16 v153, s68, v109
    v_dot2c_f32_bf16 v155, v109, v109
    v_dot2c_f32_bf16 v152, s68, v110
    v_dot2c_f32_bf16 v154, v110, v110
    v_dot2c_f32_bf16 v153, s68, v111
    v_dot2c_f32_bf16 v155, v111, v111
    s_waitcnt lgkmcnt(0)
    v_mfma_f32_32x32x16_bf16 v[48:63], v[140:143], v[100:103], v[48:63]
    ds_read_b64_tr_b16 v[128:129], v22 offset:0
    ds_read_b64_tr_b16 v[130:131], v22 offset:256
    ds_read_b64_tr_b16 v[132:133], v22 offset:4096
    ds_read_b64_tr_b16 v[134:135], v22 offset:4352
    ds_read_b64_tr_b16 v[136:137], v22 offset:8192
    ds_read_b64_tr_b16 v[138:139], v22 offset:8448
    v_mfma_f32_32x32x16_bf16 v[64:79], v[144:147], v[100:103], v[64:79]
    s_add_u32 m0, s62, 59392
    s_add_u32 s56, s54, 14336
    buffer_load_dwordx4 v45, s[8:11], s56 offen lds
    v_mul_u32_u24 v6, 3584, v192
    v_add_u32 v6, v6, v194
    s_lshl_b32 s77, s51, 7
    s_mul_i32 s72, s3, 100352
    v_mfma_f32_32x32x16_bf16 v[80:95], v[100:103], v[148:151], v[80:95]
    s_add_u32 m0, s62, 60416
    s_add_u32 s56, s54, 21504
    buffer_load_dwordx4 v46, s[8:11], s56 offen lds
    s_add_u32 s72, s72, s77
    s_mul_i32 s71, s3, 401408
    s_add_u32 s71, s71, s77
    s_and_b32 s78, s3, 1
    s_waitcnt lgkmcnt(0)
    v_mfma_f32_32x32x16_bf16 v[48:63], v[128:131], v[104:107], v[48:63]
    ds_read_b64_tr_b16 v[140:141], v23 offset:0
    ds_read_b64_tr_b16 v[142:143], v23 offset:256
    ds_read_b64_tr_b16 v[144:145], v23 offset:4096
    ds_read_b64_tr_b16 v[146:147], v23 offset:4352
    ds_read_b64_tr_b16 v[148:149], v23 offset:8192
    ds_read_b64_tr_b16 v[150:151], v23 offset:8448
    v_mfma_f32_32x32x16_bf16 v[64:79], v[132:135], v[104:107], v[64:79]
    s_add_u32 m0, s63, 57344
    s_add_u32 s56, s55, 0
    buffer_load_dwordx4 v47, s[12:15], s56 offen lds
    s_lshl_b32 s79, s78, 6
    s_add_u32 s83, s77, s79
    s_lshl_b32 s73, s78, 7
    s_lshl_b32 s77, s53, 8
    v_mfma_f32_32x32x16_bf16 v[80:95], v[104:107], v[136:139], v[80:95]
    s_add_u32 m0, s63, 61440
    s_add_u32 s56, s55, 896
    buffer_load_dwordx4 v47, s[12:15], s56 offen lds
    s_add_u32 s73, s73, s77
    s_lshr_b32 s81, s3, 1
    s_mul_i32 s82, s81, 802816
    s_add_u32 s73, s73, s82
    s_waitcnt lgkmcnt(0)
    v_mfma_f32_32x32x16_bf16 v[48:63], v[140:143], v[108:111], v[48:63]
    s_waitcnt vmcnt(10)
    s_barrier
    ds_read_b128 v[112:115], v16 offset:28672
    ds_read_b64_tr_b16 v[128:129], v20 offset:28672
    ds_read_b64_tr_b16 v[130:131], v20 offset:28928
    ds_read_b64_tr_b16 v[132:133], v20 offset:32768
    ds_read_b64_tr_b16 v[134:135], v20 offset:33024
    ds_read_b64_tr_b16 v[136:137], v20 offset:36864
    ds_read_b64_tr_b16 v[138:139], v20 offset:37120
    v_mfma_f32_32x32x16_bf16 v[64:79], v[144:147], v[108:111], v[64:79]
    ds_read_b128 v[116:119], v17 offset:28672
    ds_read_b128 v[120:123], v18 offset:28672
    ds_read_b128 v[124:127], v19 offset:28672
    v_mfma_f32_32x32x16_bf16 v[80:95], v[108:111], v[148:151], v[80:95]
    s_add_u32 m0, s63, 65536
    s_add_u32 s56, s55, 1792
    buffer_load_dwordx4 v47, s[12:15], s56 offen lds
    s_lshl_b32 s78, s78, 1
    s_add_u32 s78, s78, s81
    s_mul_i32 s67, s78, 28672
    s_mul_i32 s70, s3, 12288
    s_waitcnt lgkmcnt(3)
    v_mfma_f32_32x32x16_bf16 v[48:63], v[128:131], v[112:115], v[48:63]
    ds_read_b64_tr_b16 v[140:141], v21 offset:28672
    ds_read_b64_tr_b16 v[142:143], v21 offset:28928
    ds_read_b64_tr_b16 v[144:145], v21 offset:32768
    ds_read_b64_tr_b16 v[146:147], v21 offset:33024
    ds_read_b64_tr_b16 v[148:149], v21 offset:36864
    ds_read_b64_tr_b16 v[150:151], v21 offset:37120
    v_mfma_f32_32x32x16_bf16 v[64:79], v[132:135], v[112:115], v[64:79]
    s_lshl_b32 s54, s75, 7
    s_add_u32 s54, s54, s60
    s_mul_i32 s55, s75, 172032
    s_add_u32 s55, s55, s61
    s_add_u32 s75, s75, 1
    s_cmp_eq_u32 s75, 7
    s_cselect_b32 s75, 0, s75
    s_add_u32 m0, s62, 86016
    s_add_u32 s56, s54, 0
    buffer_load_dwordx4 v45, s[8:11], s56 offen lds
    s_add_u32 s70, s70, 114688
    s_lshl_b32 s64, s50, 1
    s_add_u32 s64, s64, s81
    s_xor_b32 s65, s64, 1
    v_mfma_f32_32x32x16_bf16 v[80:95], v[112:115], v[136:139], v[80:95]
    s_add_u32 m0, s62, 87040
    s_add_u32 s56, s54, 7168
    buffer_load_dwordx4 v46, s[8:11], s56 offen lds
    s_lshl_b32 s82, s3, 6
    s_add_u32 s82, s82, s77
    s_mul_i32 s81, s64, 28672
    s_add_u32 s81, s81, s83
    s_waitcnt lgkmcnt(6)
    v_dot2c_f32_bf16 v156, s68, v128
    v_dot2c_f32_bf16 v157, s68, v132
    v_dot2c_f32_bf16 v158, s68, v136
    v_dot2c_f32_bf16 v156, s68, v129
    v_dot2c_f32_bf16 v157, s68, v133
    v_dot2c_f32_bf16 v158, s68, v137
    v_dot2c_f32_bf16 v156, s68, v130
    v_dot2c_f32_bf16 v157, s68, v134
    v_dot2c_f32_bf16 v158, s68, v138
    v_dot2c_f32_bf16 v156, s68, v131
    v_dot2c_f32_bf16 v157, s68, v135
    v_dot2c_f32_bf16 v158, s68, v139
    v_dot2c_f32_bf16 v152, s68, v112
    v_dot2c_f32_bf16 v154, v112, v112
    v_dot2c_f32_bf16 v153, s68, v113
    v_dot2c_f32_bf16 v155, v113, v113
    v_dot2c_f32_bf16 v152, s68, v114
    v_dot2c_f32_bf16 v154, v114, v114
    v_dot2c_f32_bf16 v153, s68, v115
    v_dot2c_f32_bf16 v155, v115, v115
    v_dot2c_f32_bf16 v152, s68, v116
    v_dot2c_f32_bf16 v154, v116, v116
    v_dot2c_f32_bf16 v153, s68, v117
    v_dot2c_f32_bf16 v155, v117, v117
    v_dot2c_f32_bf16 v152, s68, v118
    v_dot2c_f32_bf16 v154, v118, v118
    v_dot2c_f32_bf16 v153, s68, v119
    v_dot2c_f32_bf16 v155, v119, v119
    v_dot2c_f32_bf16 v152, s68, v120
    v_dot2c_f32_bf16 v154, v120, v120
    v_dot2c_f32_bf16 v153, s68, v121
    v_dot2c_f32_bf16 v155, v121, v121
    v_dot2c_f32_bf16 v152, s68, v122
    v_dot2c_f32_bf16 v154, v122, v122
    v_dot2c_f32_bf16 v153, s68, v123
    v_dot2c_f32_bf16 v155, v123, v123
    v_dot2c_f32_bf16 v152, s68, v124
    v_dot2c_f32_bf16 v154, v124, v124
    v_dot2c_f32_bf16 v153, s68, v125
    v_dot2c_f32_bf16 v155, v125, v125
    v_dot2c_f32_bf16 v152, s68, v126
    v_dot2c_f32_bf16 v154, v126, v126
    v_dot2c_f32_bf16 v153, s68, v127
    v_dot2c_f32_bf16 v155, v127, v127
    s_waitcnt lgkmcnt(0)
    v_mfma_f32_32x32x16_bf16 v[48:63], v[140:143], v[116:119], v[48:63]
    ds_read_b64_tr_b16 v[128:129], v22 offset:28672
    ds_read_b64_tr_b16 v[130:131], v22 offset:28928
    ds_read_b64_tr_b16 v[132:133], v22 offset:32768
    ds_read_b64_tr_b16 v[134:135], v22 offset:33024
    ds_read_b64_tr_b16 v[136:137], v22 offset:36864
    ds_read_b64_tr_b16 v[138:139], v22 offset:37120
    v_mfma_f32_32x32x16_bf16 v[64:79], v[144:147], v[116:119], v[64:79]
    s_add_u32 m0, s62, 88064
    s_add_u32 s56, s54, 14336
    buffer_load_dwordx4 v45, s[8:11], s56 offen lds
    v_lshrrev_b32 v195, 5, v1
    v_bfe_u32 v196, v1, 2, 2
    v_lshl_add_u32 v196, v195, 2, v196
    v_lshlrev_b32_e64 v196, 7, v196
    v_mfma_f32_32x32x16_bf16 v[80:95], v[116:119], v[148:151], v[80:95]
    s_add_u32 m0, s62, 89088
    s_add_u32 s56, s54, 21504
    buffer_load_dwordx4 v46, s[8:11], s56 offen lds
    v_bfe_u32 v197, v1, 3, 1
    v_lshl_add_u32 v196, v197, 6, v196
    v_lshl_add_u32 v196, v193, 5, v196
    v_and_b32 v197, 3, v1
    s_waitcnt lgkmcnt(0)
    v_mfma_f32_32x32x16_bf16 v[48:63], v[128:131], v[120:123], v[48:63]
    ds_read_b64_tr_b16 v[140:141], v23 offset:28672
    ds_read_b64_tr_b16 v[142:143], v23 offset:28928
    ds_read_b64_tr_b16 v[144:145], v23 offset:32768
    ds_read_b64_tr_b16 v[146:147], v23 offset:33024
    ds_read_b64_tr_b16 v[148:149], v23 offset:36864
    ds_read_b64_tr_b16 v[150:151], v23 offset:37120
    v_mfma_f32_32x32x16_bf16 v[64:79], v[132:135], v[120:123], v[64:79]
    s_add_u32 m0, s63, 86016
    s_add_u32 s56, s55, 0
    buffer_load_dwordx4 v47, s[12:15], s56 offen lds
    v_lshl_add_u32 v8, v197, 3, v196
    v_xor_b32 v196, s79, v8
    v_add_u32 v7, s70, v196
    v_xor_b32 v5, 64, v7
    v_mfma_f32_32x32x16_bf16 v[80:95], v[120:123], v[136:139], v[80:95]
    s_add_u32 m0, s63, 90112
    s_add_u32 s56, s55, 896
    buffer_load_dwordx4 v47, s[12:15], s56 offen lds
    v_add_u32 v3, s67, v196
    v_xor_b32 v15, 64, v3
    v_and_b32 v196, 31, v1
    v_lshlrev_b32_e64 v199, 1, v196
    s_waitcnt lgkmcnt(0)
    v_mfma_f32_32x32x16_bf16 v[48:63], v[140:143], v[124:127], v[48:63]
    s_waitcnt vmcnt(6)
    s_barrier
    ds_read_b128 v[96:99], v24 offset:0
    ds_read_b64_tr_b16 v[128:129], v28 offset:0
    ds_read_b64_tr_b16 v[130:131], v28 offset:256
    ds_read_b64_tr_b16 v[132:133], v28 offset:4096
    ds_read_b64_tr_b16 v[134:135], v28 offset:4352
    ds_read_b64_tr_b16 v[136:137], v28 offset:8192
    ds_read_b64_tr_b16 v[138:139], v28 offset:8448
    v_mfma_f32_32x32x16_bf16 v[64:79], v[144:147], v[124:127], v[64:79]
    ds_read_b128 v[100:103], v25 offset:0
    ds_read_b128 v[104:107], v26 offset:0
    ds_read_b128 v[108:111], v27 offset:0
    v_mfma_f32_32x32x16_bf16 v[80:95], v[124:127], v[148:151], v[80:95]
    s_add_u32 m0, s63, 94208
    s_add_u32 s56, s55, 1792
    buffer_load_dwordx4 v47, s[12:15], s56 offen lds
    v_mul_u32_u24 v198, 896, v196
    v_lshl_add_u32 v198, v195, 3, v198
    s_lshl_b32 s77, s51, 1
    s_and_b32 s78, s3, 1
    s_waitcnt lgkmcnt(3)
    v_mfma_f32_32x32x16_bf16 v[48:63], v[128:131], v[96:99], v[48:63]
    ds_read_b64_tr_b16 v[140:141], v29 offset:0
    ds_read_b64_tr_b16 v[142:143], v29 offset:256
    ds_read_b64_tr_b16 v[144:145], v29 offset:4096
    ds_read_b64_tr_b16 v[146:147], v29 offset:4352
    ds_read_b64_tr_b16 v[148:149], v29 offset:8192
    ds_read_b64_tr_b16 v[150:151], v29 offset:8448
    v_mfma_f32_32x32x16_bf16 v[64:79], v[132:135], v[96:99], v[64:79]
    s_lshl_b32 s54, s75, 7
    s_add_u32 s54, s54, s60
    s_mul_i32 s55, s75, 172032
    s_add_u32 s55, s55, s61
    s_add_u32 s75, s75, 1
    s_cmp_eq_u32 s75, 7
    s_cselect_b32 s75, 0, s75
    s_add_u32 m0, s62, 114688
    s_add_u32 s56, s54, 0
    buffer_load_dwordx4 v45, s[8:11], s56 offen lds
    s_add_u32 s77, s77, s78
    s_mul_i32 s78, s64, 14
    s_add_u32 s77, s77, s78
    s_lshl_b32 s66, s77, 11
    v_mfma_f32_32x32x16_bf16 v[80:95], v[96:99], v[136:139], v[80:95]
    s_add_u32 m0, s62, 115712
    s_add_u32 s56, s54, 7168
    buffer_load_dwordx4 v46, s[8:11], s56 offen lds
    s_lshl_b32 s77, s77, 8
    s_add_u32 s77, s77, 2883584
    s_add_u32 s78, s66, 1048576
    v_lshlrev_b32 v254, 7, v1
    s_waitcnt lgkmcnt(6)
    v_dot2c_f32_bf16 v156, s68, v128
    v_dot2c_f32_bf16 v157, s68, v132
    v_dot2c_f32_bf16 v158, s68, v136
    v_dot2c_f32_bf16 v156, s68, v129
    v_dot2c_f32_bf16 v157, s68, v133
    v_dot2c_f32_bf16 v158, s68, v137
    v_dot2c_f32_bf16 v156, s68, v130
    v_dot2c_f32_bf16 v157, s68, v134
    v_dot2c_f32_bf16 v158, s68, v138
    v_dot2c_f32_bf16 v156, s68, v131
    v_dot2c_f32_bf16 v157, s68, v135
    v_dot2c_f32_bf16 v158, s68, v139
    v_dot2c_f32_bf16 v152, s68, v96
    v_dot2c_f32_bf16 v154, v96, v96
    v_dot2c_f32_bf16 v153, s68, v97
    v_dot2c_f32_bf16 v155, v97, v97
    v_dot2c_f32_bf16 v152, s68, v98
    v_dot2c_f32_bf16 v154, v98, v98
    v_dot2c_f32_bf16 v153, s68, v99
    v_dot2c_f32_bf16 v155, v99, v99
    v_dot2c_f32_bf16 v152, s68, v100
    v_dot2c_f32_bf16 v154, v100, v100
    v_dot2c_f32_bf16 v153, s68, v101
    v_dot2c_f32_bf16 v155, v101, v101
    v_dot2c_f32_bf16 v152, s68, v102
    v_dot2c_f32_bf16 v154, v102, v102
    v_dot2c_f32_bf16 v153, s68, v103
    v_dot2c_f32_bf16 v155, v103, v103
    v_dot2c_f32_bf16 v152, s68, v104
    v_dot2c_f32_bf16 v154, v104, v104
    v_dot2c_f32_bf16 v153, s68, v105
    v_dot2c_f32_bf16 v155, v105, v105
    v_dot2c_f32_bf16 v152, s68, v106
    v_dot2c_f32_bf16 v154, v106, v106
    v_dot2c_f32_bf16 v153, s68, v107
    v_dot2c_f32_bf16 v155, v107, v107
    v_dot2c_f32_bf16 v152, s68, v108
    v_dot2c_f32_bf16 v154, v108, v108
    v_dot2c_f32_bf16 v153, s68, v109
    v_dot2c_f32_bf16 v155, v109, v109
    v_dot2c_f32_bf16 v152, s68, v110
    v_dot2c_f32_bf16 v154, v110, v110
    v_dot2c_f32_bf16 v153, s68, v111
    v_dot2c_f32_bf16 v155, v111, v111
    s_waitcnt lgkmcnt(0)
    v_mfma_f32_32x32x16_bf16 v[48:63], v[140:143], v[100:103], v[48:63]
    ds_read_b64_tr_b16 v[128:129], v30 offset:0
    ds_read_b64_tr_b16 v[130:131], v30 offset:256
    ds_read_b64_tr_b16 v[132:133], v30 offset:4096
    ds_read_b64_tr_b16 v[134:135], v30 offset:4352
    ds_read_b64_tr_b16 v[136:137], v30 offset:8192
    ds_read_b64_tr_b16 v[138:139], v30 offset:8448
    v_mfma_f32_32x32x16_bf16 v[64:79], v[144:147], v[100:103], v[64:79]
    s_add_u32 m0, s62, 116736
    s_add_u32 s56, s54, 14336
    buffer_load_dwordx4 v45, s[8:11], s56 offen lds
    v_add_u32_e64 v255, s78, v254
    v_and_b32 v254, 128, v254
    v_add_u32 v254, s77, v254
    v_cmp_gt_u32 vcc, 16, v1
    s_nop 1
    v_cndmask_b32 v255, v254, v255, vcc
    v_mfma_f32_32x32x16_bf16 v[80:95], v[100:103], v[148:151], v[80:95]
    s_add_u32 m0, s62, 117760
    s_add_u32 s56, s54, 21504
    buffer_load_dwordx4 v46, s[8:11], s56 offen lds
    s_add_u32 s66, s66, 7340032
    s_xor_b32 s77, s3, 1
    s_mul_i32 s77, s77, 12288
    s_add_u32 s77, s77, 114688
    s_waitcnt lgkmcnt(0)
    v_mfma_f32_32x32x16_bf16 v[48:63], v[128:131], v[104:107], v[48:63]
    ds_read_b64_tr_b16 v[140:141], v31 offset:0
    ds_read_b64_tr_b16 v[142:143], v31 offset:256
    ds_read_b64_tr_b16 v[144:145], v31 offset:4096
    ds_read_b64_tr_b16 v[146:147], v31 offset:4352
    ds_read_b64_tr_b16 v[148:149], v31 offset:8192
    ds_read_b64_tr_b16 v[150:151], v31 offset:8448
    v_mfma_f32_32x32x16_bf16 v[64:79], v[132:135], v[104:107], v[64:79]
    s_add_u32 m0, s63, 114688
    s_add_u32 s56, s55, 0
    buffer_load_dwordx4 v47, s[12:15], s56 offen lds
    v_add_u32_e64 v11, s77, v2
    s_xor_b32 s77, s3, 2
    s_mul_i32 s77, s77, 12288
    s_add_u32 s77, s77, 118784
    v_mfma_f32_32x32x16_bf16 v[80:95], v[104:107], v[136:139], v[80:95]
    s_add_u32 m0, s63, 118784
    s_add_u32 s56, s55, 896
    buffer_load_dwordx4 v47, s[12:15], s56 offen lds
    v_add_u32 v12, s77, v2
    s_xor_b32 s77, s3, 3
    s_mul_i32 s77, s77, 12288
    s_add_u32 s77, s77, 122880
    s_waitcnt lgkmcnt(0)
    v_mfma_f32_32x32x16_bf16 v[48:63], v[140:143], v[108:111], v[48:63]
    s_waitcnt vmcnt(6)
    s_barrier
    ds_read_b128 v[112:115], v24 offset:28672
    ds_read_b64_tr_b16 v[128:129], v28 offset:28672
    ds_read_b64_tr_b16 v[130:131], v28 offset:28928
    ds_read_b64_tr_b16 v[132:133], v28 offset:32768
    ds_read_b64_tr_b16 v[134:135], v28 offset:33024
    ds_read_b64_tr_b16 v[136:137], v28 offset:36864
    ds_read_b64_tr_b16 v[138:139], v28 offset:37120
    v_mfma_f32_32x32x16_bf16 v[64:79], v[144:147], v[108:111], v[64:79]
    ds_read_b128 v[116:119], v25 offset:28672
    ds_read_b128 v[120:123], v26 offset:28672
    ds_read_b128 v[124:127], v27 offset:28672
    v_mfma_f32_32x32x16_bf16 v[80:95], v[108:111], v[148:151], v[80:95]
    s_add_u32 m0, s63, 122880
    s_add_u32 s56, s55, 1792
    buffer_load_dwordx4 v47, s[12:15], s56 offen lds
    v_add_u32 v13, s77, v2
    v_add_u32 v10, s70, v2
    v_xor_b32 v193, 1, v195
    v_lshlrev_b32 v193, 24, v193
    s_waitcnt lgkmcnt(3)
    v_mfma_f32_32x32x16_bf16 v[48:63], v[128:131], v[112:115], v[48:63]
    ds_read_b64_tr_b16 v[140:141], v29 offset:28672
    ds_read_b64_tr_b16 v[142:143], v29 offset:28928
    ds_read_b64_tr_b16 v[144:145], v29 offset:32768
    ds_read_b64_tr_b16 v[146:147], v29 offset:33024
    ds_read_b64_tr_b16 v[148:149], v29 offset:36864
    ds_read_b64_tr_b16 v[150:151], v29 offset:37120
    v_mfma_f32_32x32x16_bf16 v[64:79], v[132:135], v[112:115], v[64:79]
    s_lshl_b32 s54, s75, 7
    s_add_u32 s54, s54, s60
    s_mul_i32 s55, s75, 172032
    s_add_u32 s55, s55, s61
    s_add_u32 s75, s75, 1
    s_cmp_eq_u32 s75, 7
    s_cselect_b32 s75, 0, s75
    s_add_u32 m0, s62, 0
    s_add_u32 s56, s54, 0
    buffer_load_dwordx4 v45, s[8:11], s56 offen lds
    v_lshl_add_u32 v9, v196, 7, v193
    v_lshrrev_b32_e64 v194, 2, v196
    v_lshl_add_u32 v194, v194, 4, v197
    v_lshl_add_u32 v14, v194, 7, v193
    v_mfma_f32_32x32x16_bf16 v[80:95], v[112:115], v[136:139], v[80:95]
    s_add_u32 m0, s62, 1024
    s_add_u32 s56, s54, 7168
    buffer_load_dwordx4 v46, s[8:11], s56 offen lds
    s_lshl_b32 s69, s48, 19
    s_lshl_b32 s77, s49, 14
    s_add_u32 s69, s69, s77
    s_lshl_b32 s77, s3, 12
    s_waitcnt lgkmcnt(6)
    v_dot2c_f32_bf16 v156, s68, v128
    v_dot2c_f32_bf16 v157, s68, v132
    v_dot2c_f32_bf16 v158, s68, v136
    v_dot2c_f32_bf16 v156, s68, v129
    v_dot2c_f32_bf16 v157, s68, v133
    v_dot2c_f32_bf16 v158, s68, v137
    v_dot2c_f32_bf16 v156, s68, v130
    v_dot2c_f32_bf16 v157, s68, v134
    v_dot2c_f32_bf16 v158, s68, v138
    v_dot2c_f32_bf16 v156, s68, v131
    v_dot2c_f32_bf16 v157, s68, v135
    v_dot2c_f32_bf16 v158, s68, v139
    v_dot2c_f32_bf16 v152, s68, v112
    v_dot2c_f32_bf16 v154, v112, v112
    v_dot2c_f32_bf16 v153, s68, v113
    v_dot2c_f32_bf16 v155, v113, v113
    v_dot2c_f32_bf16 v152, s68, v114
    v_dot2c_f32_bf16 v154, v114, v114
    v_dot2c_f32_bf16 v153, s68, v115
    v_dot2c_f32_bf16 v155, v115, v115
    v_dot2c_f32_bf16 v152, s68, v116
    v_dot2c_f32_bf16 v154, v116, v116
    v_dot2c_f32_bf16 v153, s68, v117
    v_dot2c_f32_bf16 v155, v117, v117
    v_dot2c_f32_bf16 v152, s68, v118
    v_dot2c_f32_bf16 v154, v118, v118
    v_dot2c_f32_bf16 v153, s68, v119
    v_dot2c_f32_bf16 v155, v119, v119
    v_dot2c_f32_bf16 v152, s68, v120
    v_dot2c_f32_bf16 v154, v120, v120
    v_dot2c_f32_bf16 v153, s68, v121
    v_dot2c_f32_bf16 v155, v121, v121
    v_dot2c_f32_bf16 v152, s68, v122
    v_dot2c_f32_bf16 v154, v122, v122
    v_dot2c_f32_bf16 v153, s68, v123
    v_dot2c_f32_bf16 v155, v123, v123
    v_dot2c_f32_bf16 v152, s68, v124
    v_dot2c_f32_bf16 v154, v124, v124
    v_dot2c_f32_bf16 v153, s68, v125
    v_dot2c_f32_bf16 v155, v125, v125
    v_dot2c_f32_bf16 v152, s68, v126
    v_dot2c_f32_bf16 v154, v126, v126
    v_dot2c_f32_bf16 v153, s68, v127
    v_dot2c_f32_bf16 v155, v127, v127
    s_waitcnt lgkmcnt(0)
    v_mfma_f32_32x32x16_bf16 v[48:63], v[140:143], v[116:119], v[48:63]
    ds_read_b64_tr_b16 v[128:129], v30 offset:28672
    ds_read_b64_tr_b16 v[130:131], v30 offset:28928
    ds_read_b64_tr_b16 v[132:133], v30 offset:32768
    ds_read_b64_tr_b16 v[134:135], v30 offset:33024
    ds_read_b64_tr_b16 v[136:137], v30 offset:36864
    ds_read_b64_tr_b16 v[138:139], v30 offset:37120
    v_mfma_f32_32x32x16_bf16 v[64:79], v[144:147], v[116:119], v[64:79]
    s_add_u32 m0, s62, 2048
    s_add_u32 s56, s54, 14336
    buffer_load_dwordx4 v45, s[8:11], s56 offen lds
    s_add_u32 s69, s69, s77
    s_add_u32 s69, s69, 18874368
    s_bitcmp1_b32 s3, 0
    s_cselect_b32 s84, 1, 0
    s_cselect_b32 s85, 3, 2
    s_cselect_b32 s86, 5, 4
    s_cselect_b32 s87, 0, 6
    s_cselect_b32 s88, 2, 1
    s_cselect_b32 s89, 4, 3
    s_cselect_b32 s90, 6, 5
    s_mul_i32 s91, s84, 57344
    v_mfma_f32_32x32x16_bf16 v[80:95], v[116:119], v[148:151], v[80:95]
    s_add_u32 m0, s62, 3072
    s_add_u32 s56, s54, 21504
    buffer_load_dwordx4 v46, s[8:11], s56 offen lds
    s_add_u32 s91, s91, s71
    s_lshl_b32 s84, s84, 12
    s_mul_i32 s92, s85, 57344
    s_add_u32 s92, s92, s71
    s_waitcnt lgkmcnt(0)
    v_mfma_f32_32x32x16_bf16 v[48:63], v[128:131], v[120:123], v[48:63]
    ds_read_b64_tr_b16 v[140:141], v31 offset:28672
    ds_read_b64_tr_b16 v[142:143], v31 offset:28928
    ds_read_b64_tr_b16 v[144:145], v31 offset:32768
    ds_read_b64_tr_b16 v[146:147], v31 offset:33024
    ds_read_b64_tr_b16 v[148:149], v31 offset:36864
    ds_read_b64_tr_b16 v[150:151], v31 offset:37120
    v_mfma_f32_32x32x16_bf16 v[64:79], v[132:135], v[120:123], v[64:79]
    s_add_u32 m0, s63, 0
    s_add_u32 s56, s55, 0
    buffer_load_dwordx4 v47, s[12:15], s56 offen lds
    s_lshl_b32 s85, s85, 12
    s_mul_i32 s93, s86, 57344
    s_add_u32 s93, s93, s71
    s_lshl_b32 s86, s86, 12
    v_mfma_f32_32x32x16_bf16 v[80:95], v[120:123], v[136:139], v[80:95]
    s_add_u32 m0, s63, 4096
    s_add_u32 s56, s55, 896
    buffer_load_dwordx4 v47, s[12:15], s56 offen lds
    s_mul_i32 s94, s87, 57344
    s_add_u32 s94, s94, s71
    s_lshl_b32 s87, s87, 12
    s_mul_i32 s95, s88, 57344
    s_waitcnt lgkmcnt(0)
    v_mfma_f32_32x32x16_bf16 v[48:63], v[140:143], v[124:127], v[48:63]
    s_waitcnt vmcnt(6)
    s_barrier
    ds_read_b128 v[96:99], v32 offset:0
    ds_read_b64_tr_b16 v[128:129], v36 offset:0
    ds_read_b64_tr_b16 v[130:131], v36 offset:256
    ds_read_b64_tr_b16 v[132:133], v36 offset:4096
    ds_read_b64_tr_b16 v[134:135], v36 offset:4352
    ds_read_b64_tr_b16 v[136:137], v36 offset:8192
    ds_read_b64_tr_b16 v[138:139], v36 offset:8448
    v_mfma_f32_32x32x16_bf16 v[64:79], v[144:147], v[124:127], v[64:79]
    ds_read_b128 v[100:103], v33 offset:0
    ds_read_b128 v[104:107], v34 offset:0
    ds_read_b128 v[108:111], v35 offset:0
    v_mfma_f32_32x32x16_bf16 v[80:95], v[124:127], v[148:151], v[80:95]
    s_add_u32 m0, s63, 8192
    s_add_u32 s56, s55, 1792
    buffer_load_dwordx4 v47, s[12:15], s56 offen lds
    s_add_u32 s95, s95, s71
    s_lshl_b32 s88, s88, 12
    s_mul_i32 s96, s89, 57344
    s_add_u32 s96, s96, s71
    s_waitcnt lgkmcnt(3)
    v_mfma_f32_32x32x16_bf16 v[48:63], v[128:131], v[96:99], v[48:63]
    ds_read_b64_tr_b16 v[140:141], v37 offset:0
    ds_read_b64_tr_b16 v[142:143], v37 offset:256
    ds_read_b64_tr_b16 v[144:145], v37 offset:4096
    ds_read_b64_tr_b16 v[146:147], v37 offset:4352
    ds_read_b64_tr_b16 v[148:149], v37 offset:8192
    ds_read_b64_tr_b16 v[150:151], v37 offset:8448
    v_mfma_f32_32x32x16_bf16 v[64:79], v[132:135], v[96:99], v[64:79]
    s_lshl_b32 s54, s75, 7
    s_add_u32 s54, s54, s60
    s_mul_i32 s55, s75, 172032
    s_add_u32 s55, s55, s61
    s_add_u32 s75, s75, 1
    s_cmp_eq_u32 s75, 7
    s_cselect_b32 s75, 0, s75
    s_add_u32 m0, s62, 28672
    s_add_u32 s56, s54, 0
    buffer_load_dwordx4 v45, s[8:11], s56 offen lds
    s_lshl_b32 s89, s89, 12
    s_mul_i32 s97, s90, 57344
    s_add_u32 s97, s97, s71
    s_lshl_b32 s90, s90, 12
    v_mfma_f32_32x32x16_bf16 v[80:95], v[96:99], v[136:139], v[80:95]
    s_add_u32 m0, s62, 29696
    s_add_u32 s56, s54, 7168
    buffer_load_dwordx4 v46, s[8:11], s56 offen lds
    s_waitcnt lgkmcnt(6)
    v_dot2c_f32_bf16 v156, s68, v128
    v_dot2c_f32_bf16 v157, s68, v132
    v_dot2c_f32_bf16 v158, s68, v136
    v_dot2c_f32_bf16 v156, s68, v129
    v_dot2c_f32_bf16 v157, s68, v133
    v_dot2c_f32_bf16 v158, s68, v137
    v_dot2c_f32_bf16 v156, s68, v130
    v_dot2c_f32_bf16 v157, s68, v134
    v_dot2c_f32_bf16 v158, s68, v138
    v_dot2c_f32_bf16 v156, s68, v131
    v_dot2c_f32_bf16 v157, s68, v135
    v_dot2c_f32_bf16 v158, s68, v139
    v_dot2c_f32_bf16 v152, s68, v96
    v_dot2c_f32_bf16 v154, v96, v96
    v_dot2c_f32_bf16 v153, s68, v97
    v_dot2c_f32_bf16 v155, v97, v97
    v_dot2c_f32_bf16 v152, s68, v98
    v_dot2c_f32_bf16 v154, v98, v98
    v_dot2c_f32_bf16 v153, s68, v99
    v_dot2c_f32_bf16 v155, v99, v99
    v_dot2c_f32_bf16 v152, s68, v100
    v_dot2c_f32_bf16 v154, v100, v100
    v_dot2c_f32_bf16 v153, s68, v101
    v_dot2c_f32_bf16 v155, v101, v101
    v_dot2c_f32_bf16 v152, s68, v102
    v_dot2c_f32_bf16 v154, v102, v102
    v_dot2c_f32_bf16 v153, s68, v103
    v_dot2c_f32_bf16 v155, v103, v103
    v_dot2c_f32_bf16 v152, s68, v104
    v_dot2c_f32_bf16 v154, v104, v104
    v_dot2c_f32_bf16 v153, s68, v105
    v_dot2c_f32_bf16 v155, v105, v105
    v_dot2c_f32_bf16 v152, s68, v106
    v_dot2c_f32_bf16 v154, v106, v106
    v_dot2c_f32_bf16 v153, s68, v107
    v_dot2c_f32_bf16 v155, v107, v107
    v_dot2c_f32_bf16 v152, s68, v108
    v_dot2c_f32_bf16 v154, v108, v108
    v_dot2c_f32_bf16 v153, s68, v109
    v_dot2c_f32_bf16 v155, v109, v109
    v_dot2c_f32_bf16 v152, s68, v110
    v_dot2c_f32_bf16 v154, v110, v110
    v_dot2c_f32_bf16 v153, s68, v111
    v_dot2c_f32_bf16 v155, v111, v111
    s_waitcnt lgkmcnt(0)
    v_mfma_f32_32x32x16_bf16 v[48:63], v[140:143], v[100:103], v[48:63]
    ds_read_b64_tr_b16 v[128:129], v38 offset:0
    ds_read_b64_tr_b16 v[130:131], v38 offset:256
    ds_read_b64_tr_b16 v[132:133], v38 offset:4096
    ds_read_b64_tr_b16 v[134:135], v38 offset:4352
    ds_read_b64_tr_b16 v[136:137], v38 offset:8192
    ds_read_b64_tr_b16 v[138:139], v38 offset:8448
    v_mfma_f32_32x32x16_bf16 v[64:79], v[144:147], v[100:103], v[64:79]
    s_add_u32 m0, s62, 30720
    s_add_u32 s56, s54, 14336
    buffer_load_dwordx4 v45, s[8:11], s56 offen lds
    v_mfma_f32_32x32x16_bf16 v[80:95], v[100:103], v[148:151], v[80:95]
    s_add_u32 m0, s62, 31744
    s_add_u32 s56, s54, 21504
    buffer_load_dwordx4 v46, s[8:11], s56 offen lds
    s_waitcnt lgkmcnt(0)
    v_mfma_f32_32x32x16_bf16 v[48:63], v[128:131], v[104:107], v[48:63]
    ds_read_b64_tr_b16 v[140:141], v39 offset:0
    ds_read_b64_tr_b16 v[142:143], v39 offset:256
    ds_read_b64_tr_b16 v[144:145], v39 offset:4096
    ds_read_b64_tr_b16 v[146:147], v39 offset:4352
    ds_read_b64_tr_b16 v[148:149], v39 offset:8192
    ds_read_b64_tr_b16 v[150:151], v39 offset:8448
    v_mfma_f32_32x32x16_bf16 v[64:79], v[132:135], v[104:107], v[64:79]
    s_add_u32 m0, s63, 28672
    s_add_u32 s56, s55, 0
    buffer_load_dwordx4 v47, s[12:15], s56 offen lds
    v_mfma_f32_32x32x16_bf16 v[80:95], v[104:107], v[136:139], v[80:95]
    s_add_u32 m0, s63, 32768
    s_add_u32 s56, s55, 896
    buffer_load_dwordx4 v47, s[12:15], s56 offen lds
    s_waitcnt lgkmcnt(0)
    v_mfma_f32_32x32x16_bf16 v[48:63], v[140:143], v[108:111], v[48:63]
    s_waitcnt vmcnt(6)
    s_barrier
    ds_read_b128 v[112:115], v16 offset:0
    ds_read_b64_tr_b16 v[128:129], v20 offset:0
    ds_read_b64_tr_b16 v[130:131], v20 offset:256
    ds_read_b64_tr_b16 v[132:133], v20 offset:4096
    ds_read_b64_tr_b16 v[134:135], v20 offset:4352
    ds_read_b64_tr_b16 v[136:137], v20 offset:8192
    ds_read_b64_tr_b16 v[138:139], v20 offset:8448
    v_mfma_f32_32x32x16_bf16 v[64:79], v[144:147], v[108:111], v[64:79]
    ds_read_b128 v[116:119], v17 offset:0
    ds_read_b128 v[120:123], v18 offset:0
    ds_read_b128 v[124:127], v19 offset:0
    v_mfma_f32_32x32x16_bf16 v[80:95], v[108:111], v[148:151], v[80:95]
    s_add_u32 m0, s63, 36864
    s_add_u32 s56, s55, 1792
    buffer_load_dwordx4 v47, s[12:15], s56 offen lds
    s_waitcnt lgkmcnt(3)
    v_mfma_f32_32x32x16_bf16 v[48:63], v[128:131], v[112:115], v[48:63]
    ds_read_b64_tr_b16 v[140:141], v21 offset:0
    ds_read_b64_tr_b16 v[142:143], v21 offset:256
    ds_read_b64_tr_b16 v[144:145], v21 offset:4096
    ds_read_b64_tr_b16 v[146:147], v21 offset:4352
    ds_read_b64_tr_b16 v[148:149], v21 offset:8192
    ds_read_b64_tr_b16 v[150:151], v21 offset:8448
    v_mfma_f32_32x32x16_bf16 v[64:79], v[132:135], v[112:115], v[64:79]
    s_and_b32 s56, s2, 7
    s_lshl_b32 s56, s56, 5
    s_lshr_b32 s57, s2, 3
    s_add_u32 s58, s56, s57
    s_mul_i32 s56, s58, 6272
    s_mul_i32 s57, s3, 1568
    s_add_u32 s56, s56, s57
    buffer_load_dwordx4 a[0:3], v2, s[20:23], s56 offen
    v_mfma_f32_32x32x16_bf16 v[80:95], v[112:115], v[136:139], v[80:95]
    buffer_load_dwordx4 a[4:7], v2, s[20:23], s56 offen offset:544
    s_waitcnt lgkmcnt(6)
    v_dot2c_f32_bf16 v156, s68, v128
    v_dot2c_f32_bf16 v157, s68, v132
    v_dot2c_f32_bf16 v158, s68, v136
    v_dot2c_f32_bf16 v156, s68, v129
    v_dot2c_f32_bf16 v157, s68, v133
    v_dot2c_f32_bf16 v158, s68, v137
    v_dot2c_f32_bf16 v156, s68, v130
    v_dot2c_f32_bf16 v157, s68, v134
    v_dot2c_f32_bf16 v158, s68, v138
    v_dot2c_f32_bf16 v156, s68, v131
    v_dot2c_f32_bf16 v157, s68, v135
    v_dot2c_f32_bf16 v158, s68, v139
    v_dot2c_f32_bf16 v152, s68, v112
    v_dot2c_f32_bf16 v154, v112, v112
    v_dot2c_f32_bf16 v153, s68, v113
    v_dot2c_f32_bf16 v155, v113, v113
    v_dot2c_f32_bf16 v152, s68, v114
    v_dot2c_f32_bf16 v154, v114, v114
    v_dot2c_f32_bf16 v153, s68, v115
    v_dot2c_f32_bf16 v155, v115, v115
    v_dot2c_f32_bf16 v152, s68, v116
    v_dot2c_f32_bf16 v154, v116, v116
    v_dot2c_f32_bf16 v153, s68, v117
    v_dot2c_f32_bf16 v155, v117, v117
    v_dot2c_f32_bf16 v152, s68, v118
    v_dot2c_f32_bf16 v154, v118, v118
    v_dot2c_f32_bf16 v153, s68, v119
    v_dot2c_f32_bf16 v155, v119, v119
    v_dot2c_f32_bf16 v152, s68, v120
    v_dot2c_f32_bf16 v154, v120, v120
    v_dot2c_f32_bf16 v153, s68, v121
    v_dot2c_f32_bf16 v155, v121, v121
    v_dot2c_f32_bf16 v152, s68, v122
    v_dot2c_f32_bf16 v154, v122, v122
    v_dot2c_f32_bf16 v153, s68, v123
    v_dot2c_f32_bf16 v155, v123, v123
    v_dot2c_f32_bf16 v152, s68, v124
    v_dot2c_f32_bf16 v154, v124, v124
    v_dot2c_f32_bf16 v153, s68, v125
    v_dot2c_f32_bf16 v155, v125, v125
    v_dot2c_f32_bf16 v152, s68, v126
    v_dot2c_f32_bf16 v154, v126, v126
    v_dot2c_f32_bf16 v153, s68, v127
    v_dot2c_f32_bf16 v155, v127, v127
    s_waitcnt lgkmcnt(0)
    v_mfma_f32_32x32x16_bf16 v[48:63], v[140:143], v[116:119], v[48:63]
    ds_read_b64_tr_b16 v[128:129], v22 offset:0
    ds_read_b64_tr_b16 v[130:131], v22 offset:256
    ds_read_b64_tr_b16 v[132:133], v22 offset:4096
    ds_read_b64_tr_b16 v[134:135], v22 offset:4352
    ds_read_b64_tr_b16 v[136:137], v22 offset:8192
    ds_read_b64_tr_b16 v[138:139], v22 offset:8448
    v_mfma_f32_32x32x16_bf16 v[64:79], v[144:147], v[116:119], v[64:79]
    buffer_load_dwordx4 a[0:3], v2, s[24:27], s56 offen
    v_mfma_f32_32x32x16_bf16 v[80:95], v[116:119], v[148:151], v[80:95]
    buffer_load_dwordx4 a[4:7], v2, s[24:27], s56 offen offset:544
    s_waitcnt lgkmcnt(0)
    v_mfma_f32_32x32x16_bf16 v[48:63], v[128:131], v[120:123], v[48:63]
    ds_read_b64_tr_b16 v[140:141], v23 offset:0
    ds_read_b64_tr_b16 v[142:143], v23 offset:256
    ds_read_b64_tr_b16 v[144:145], v23 offset:4096
    ds_read_b64_tr_b16 v[146:147], v23 offset:4352
    ds_read_b64_tr_b16 v[148:149], v23 offset:8192
    ds_read_b64_tr_b16 v[150:151], v23 offset:8448
    v_mfma_f32_32x32x16_bf16 v[64:79], v[132:135], v[120:123], v[64:79]
    s_mul_i32 s56, s58, 1568
    s_mul_i32 s57, s3, 392
    s_add_u32 s56, s56, s57
    v_lshlrev_b32_e64 v232, 3, v1
    buffer_load_dwordx2 a[8:9], v232, s[16:19], s56 offen
    v_mfma_f32_32x32x16_bf16 v[80:95], v[120:123], v[136:139], v[80:95]
    buffer_load_dwordx2 v[240:241], v198, s[8:11], s81 offen offset:0
    buffer_load_dwordx2 v[242:243], v198, s[8:11], s81 offen offset:16
    buffer_load_dwordx2 v[244:245], v198, s[8:11], s81 offen offset:32
    buffer_load_dwordx2 v[246:247], v198, s[8:11], s81 offen offset:48
    s_waitcnt lgkmcnt(0)
    v_mfma_f32_32x32x16_bf16 v[48:63], v[140:143], v[124:127], v[48:63]
    s_waitcnt vmcnt(9)
    s_barrier
    ds_read_b128 v[96:99], v16 offset:28672
    ds_read_b64_tr_b16 v[128:129], v20 offset:28672
    ds_read_b64_tr_b16 v[130:131], v20 offset:28928
    ds_read_b64_tr_b16 v[132:133], v20 offset:32768
    ds_read_b64_tr_b16 v[134:135], v20 offset:33024
    ds_read_b64_tr_b16 v[136:137], v20 offset:36864
    ds_read_b64_tr_b16 v[138:139], v20 offset:37120
    v_mfma_f32_32x32x16_bf16 v[64:79], v[144:147], v[124:127], v[64:79]
    ds_read_b128 v[100:103], v17 offset:28672
    ds_read_b128 v[104:107], v18 offset:28672
    ds_read_b128 v[108:111], v19 offset:28672
    v_mfma_f32_32x32x16_bf16 v[80:95], v[124:127], v[148:151], v[80:95]
    buffer_load_ushort v248, v199, s[40:43], s82 offen
    buffer_load_ushort v251, v199, s[44:47], s83 offen
    buffer_load_dwordx2 v[234:235], v187, s[36:39], 0 offen sc1
    s_waitcnt lgkmcnt(3)
    v_mfma_f32_32x32x16_bf16 v[48:63], v[128:131], v[96:99], v[48:63]
    ds_read_b64_tr_b16 v[140:141], v21 offset:28672
    ds_read_b64_tr_b16 v[142:143], v21 offset:28928
    ds_read_b64_tr_b16 v[144:145], v21 offset:32768
    ds_read_b64_tr_b16 v[146:147], v21 offset:33024
    ds_read_b64_tr_b16 v[148:149], v21 offset:36864
    ds_read_b64_tr_b16 v[150:151], v21 offset:37120
    v_mfma_f32_32x32x16_bf16 v[64:79], v[132:135], v[96:99], v[64:79]
    v_mfma_f32_32x32x16_bf16 v[80:95], v[96:99], v[136:139], v[80:95]
    s_waitcnt lgkmcnt(6)
    v_dot2c_f32_bf16 v156, s68, v128
    v_dot2c_f32_bf16 v157, s68, v132
    v_dot2c_f32_bf16 v158, s68, v136
    v_dot2c_f32_bf16 v156, s68, v129
    v_dot2c_f32_bf16 v157, s68, v133
    v_dot2c_f32_bf16 v158, s68, v137
    v_dot2c_f32_bf16 v156, s68, v130
    v_dot2c_f32_bf16 v157, s68, v134
    v_dot2c_f32_bf16 v158, s68, v138
    v_dot2c_f32_bf16 v156, s68, v131
    v_dot2c_f32_bf16 v157, s68, v135
    v_dot2c_f32_bf16 v158, s68, v139
    v_dot2c_f32_bf16 v152, s68, v96
    v_dot2c_f32_bf16 v154, v96, v96
    v_dot2c_f32_bf16 v153, s68, v97
    v_dot2c_f32_bf16 v155, v97, v97
    v_dot2c_f32_bf16 v152, s68, v98
    v_dot2c_f32_bf16 v154, v98, v98
    v_dot2c_f32_bf16 v153, s68, v99
    v_dot2c_f32_bf16 v155, v99, v99
    v_dot2c_f32_bf16 v152, s68, v100
    v_dot2c_f32_bf16 v154, v100, v100
    v_dot2c_f32_bf16 v153, s68, v101
    v_dot2c_f32_bf16 v155, v101, v101
    v_dot2c_f32_bf16 v152, s68, v102
    v_dot2c_f32_bf16 v154, v102, v102
    v_dot2c_f32_bf16 v153, s68, v103
    v_dot2c_f32_bf16 v155, v103, v103
    v_dot2c_f32_bf16 v152, s68, v104
    v_dot2c_f32_bf16 v154, v104, v104
    v_dot2c_f32_bf16 v153, s68, v105
    v_dot2c_f32_bf16 v155, v105, v105
    v_dot2c_f32_bf16 v152, s68, v106
    v_dot2c_f32_bf16 v154, v106, v106
    v_dot2c_f32_bf16 v153, s68, v107
    v_dot2c_f32_bf16 v155, v107, v107
    v_dot2c_f32_bf16 v152, s68, v108
    v_dot2c_f32_bf16 v154, v108, v108
    v_dot2c_f32_bf16 v153, s68, v109
    v_dot2c_f32_bf16 v155, v109, v109
    v_dot2c_f32_bf16 v152, s68, v110
    v_dot2c_f32_bf16 v154, v110, v110
    v_dot2c_f32_bf16 v153, s68, v111
    v_dot2c_f32_bf16 v155, v111, v111
    s_waitcnt lgkmcnt(0)
    v_mfma_f32_32x32x16_bf16 v[48:63], v[140:143], v[100:103], v[48:63]
    ds_read_b64_tr_b16 v[128:129], v22 offset:28672
    ds_read_b64_tr_b16 v[130:131], v22 offset:28928
    ds_read_b64_tr_b16 v[132:133], v22 offset:32768
    ds_read_b64_tr_b16 v[134:135], v22 offset:33024
    ds_read_b64_tr_b16 v[136:137], v22 offset:36864
    ds_read_b64_tr_b16 v[138:139], v22 offset:37120
    v_mfma_f32_32x32x16_bf16 v[64:79], v[144:147], v[100:103], v[64:79]
    ds_write_b32 v182, v156 offset:0
    ds_write_b32 v182, v157 offset:1024
    ds_write_b32 v182, v158 offset:2048
    v_add_f32 v152, v152, v153
    v_add_f32 v154, v154, v155
    v_mov_b32_e64 v153, v152
    v_mfma_f32_32x32x16_bf16 v[80:95], v[100:103], v[148:151], v[80:95]
    v_mov_b32_e64 v155, v154
    s_waitcnt lgkmcnt(0)
    s_barrier
    ds_read_b128 v[192:195], v184 offset:0
    ds_read_b128 v[196:199], v184 offset:16
    ds_read_b128 v[200:203], v184 offset:1024
    v_mfma_f32_32x32x16_bf16 v[48:63], v[128:131], v[104:107], v[48:63]
    ds_read_b64_tr_b16 v[140:141], v23 offset:28672
    ds_read_b64_tr_b16 v[142:143], v23 offset:28928
    ds_read_b64_tr_b16 v[144:145], v23 offset:32768
    ds_read_b64_tr_b16 v[146:147], v23 offset:33024
    ds_read_b64_tr_b16 v[148:149], v23 offset:36864
    ds_read_b64_tr_b16 v[150:151], v23 offset:37120
    v_mfma_f32_32x32x16_bf16 v[64:79], v[132:135], v[104:107], v[64:79]
    ds_read_b128 v[204:207], v184 offset:1040
    ds_read_b128 v[208:211], v184 offset:2048
    ds_read_b128 v[212:215], v184 offset:2064
    v_permlane32_swap_b32 v152, v153
    v_permlane32_swap_b32 v154, v155
    v_add_f32_e64 v152, v152, v153
    v_mfma_f32_32x32x16_bf16 v[80:95], v[104:107], v[136:139], v[80:95]
    v_add_f32_e64 v154, v154, v155
    v_mul_f32 v152, 0xbb124925, v152
    v_mul_f32 v154, 0x3b124925, v154
    v_fma_f32 v154, -v152, v152, v154
    v_max_f32_e64 v154, 0, v154
    v_add_f32 v154, 0x3727c5ac, v154
    s_waitcnt lgkmcnt(3)
    v_mfma_f32_32x32x16_bf16 v[48:63], v[140:143], v[108:111], v[48:63]
    v_rsq_f32 v158, v154
    v_cvt_pk_bf16_f32 v164, v152, v152
    ds_write_b32 v183, v158
    v_lshlrev_b32 v153, 16, v164
    v_sub_f32 v153, v152, v153
    v_mfma_f32_32x32x16_bf16 v[64:79], v[144:147], v[108:111], v[64:79]
    v_cvt_pk_bf16_f32 v165, v153, v153
    s_mov_b32 s60, 0
    s_mov_b32 s61, -1
    v_cndmask_b32 v164, v164, v187, s[60:61]
    v_cndmask_b32 v165, v165, v187, s[60:61]
    ds_read_b128 v[216:219], v185 offset:0
    v_mfma_f32_32x32x16_bf16 v[80:95], v[108:111], v[148:151], v[80:95]
    ds_read_b128 v[220:223], v185 offset:32
    ds_read_b128 v[224:227], v185 offset:64
    ds_read_b128 v[228:231], v185 offset:96
    s_waitcnt lgkmcnt(7)
    v_add_f32 v200, v200, v204
    v_add_f32 v201, v201, v205
    v_add_f32 v202, v202, v206
    v_add_f32 v203, v203, v207
    v_add_f32 v200, v200, v201
    v_add_f32 v202, v202, v203
    v_add_f32 v200, v200, v202
    v_cvt_pk_bf16_f32 v201, v200, v200
    v_lshlrev_b32 v201, 16, v201
    v_sub_f32 v201, v200, v201
    v_cvt_pk_bf16_f32 v172, v200, v201
    v_mov_b32 v173, v172
    s_nop 1
    v_mfma_f32_32x32x16_bf16 v[64:79], v[172:175], v[164:167], v[64:79]
    s_waitcnt lgkmcnt(5)
    v_add_f32 v208, v208, v212
    v_add_f32 v209, v209, v213
    v_add_f32 v210, v210, v214
    v_add_f32 v211, v211, v215
    v_add_f32 v208, v208, v209
    v_add_f32 v210, v210, v211
    v_add_f32 v208, v208, v210
    v_cvt_pk_bf16_f32 v209, v208, v208
    v_lshlrev_b32 v209, 16, v209
    v_sub_f32 v209, v208, v209
    v_cvt_pk_bf16_f32 v176, v208, v209
    v_mov_b32 v177, v176
    s_nop 1
    v_mfma_f32_32x32x16_bf16 v[80:95], v[164:167], v[176:179], v[80:95]
    v_add_f32 v192, v192, v196
    v_add_f32 v193, v193, v197
    v_add_f32 v194, v194, v198
    v_add_f32 v195, v195, v199
    v_add_f32 v192, v192, v193
    v_add_f32 v194, v194, v195
    v_add_f32_e64 v192, v192, v194
    v_cvt_pk_bf16_f32 v193, v192, v192
    v_lshlrev_b32 v193, 16, v193
    v_sub_f32 v193, v192, v193
    v_cvt_pk_bf16_f32 v168, v192, v193
    v_mov_b32 v169, v168
    s_nop 1
    v_mfma_f32_32x32x16_bf16 v[48:63], v[168:171], v[164:167], v[48:63]
    s_mov_b32 s62, 0xf0000000
    s_mov_b32 s63, 0xf0000000
    s_mov_b32 s58, s76
    s_mov_b32 s59, s69
    v_mul_f32 v64, v64, v158
    v_mul_f32 v65, v65, v158
    v_cvt_pk_bf16_f32 v160, v64, v65
    v_mul_f32 v66, v66, v158
    v_mul_f32 v67, v67, v158
    v_cvt_pk_bf16_f32 v161, v66, v67
    v_mul_f32 v68, v68, v158
    v_mul_f32 v69, v69, v158
    v_cvt_pk_bf16_f32 v162, v68, v69
    v_mul_f32 v70, v70, v158
    v_mul_f32 v71, v71, v158
    v_cvt_pk_bf16_f32 v163, v70, v71
    buffer_store_dwordx4 v[160:163], v2, s[28:31], s59 offen sc1
    v_mul_f32 v72, v72, v158
    v_mul_f32 v73, v73, v158
    v_cvt_pk_bf16_f32 v164, v72, v73
    v_mul_f32 v74, v74, v158
    v_mul_f32 v75, v75, v158
    v_cvt_pk_bf16_f32 v165, v74, v75
    v_mul_f32 v76, v76, v158
    v_mul_f32 v77, v77, v158
    v_cvt_pk_bf16_f32 v166, v76, v77
    v_mul_f32 v78, v78, v158
    v_mul_f32 v79, v79, v158
    v_cvt_pk_bf16_f32 v167, v78, v79
    v_cndmask_b32 v166, v166, v188, s[60:61]
    v_cndmask_b32 v167, v167, v187, s[60:61]
    buffer_store_dwordx4 v[164:167], v2, s[28:31], s59 offen offset:1024 sc1
    s_waitcnt lgkmcnt(0)
    v_pk_mul_f32 v[80:81], v[80:81], v[216:217]
    v_pk_mul_f32 v[82:83], v[82:83], v[218:219]
    v_pk_mul_f32 v[84:85], v[84:85], v[220:221]
    v_pk_mul_f32 v[86:87], v[86:87], v[222:223]
    v_pk_mul_f32 v[88:89], v[88:89], v[224:225]
    v_pk_mul_f32 v[90:91], v[90:91], v[226:227]
    v_pk_mul_f32 v[92:93], v[92:93], v[228:229]
    v_pk_mul_f32 v[94:95], v[94:95], v[230:231]
    v_cvt_pk_bf16_f32 v168, v80, v81
    v_cndmask_b32 v168, v168, v186, s[62:63]
    v_cvt_pk_bf16_f32 v169, v82, v83
    v_cndmask_b32 v169, v169, v186, s[62:63]
    v_cvt_pk_bf16_f32 v170, v84, v85
    v_cndmask_b32 v170, v170, v186, s[62:63]
    v_cvt_pk_bf16_f32 v171, v86, v87
    v_cndmask_b32 v171, v171, v186, s[62:63]
    buffer_store_dwordx4 v[168:171], v2, s[28:31], s59 offen offset:2048 sc1
    v_cvt_pk_bf16_f32 v172, v88, v89
    v_cndmask_b32 v172, v172, v186, s[62:63]
    v_cvt_pk_bf16_f32 v173, v90, v91
    v_cndmask_b32 v173, v173, v186, s[62:63]
    v_cvt_pk_bf16_f32 v174, v92, v93
    v_cndmask_b32 v174, v174, v186, s[62:63]
    v_cvt_pk_bf16_f32 v175, v94, v95
    v_cndmask_b32 v175, v175, v186, s[62:63]
    buffer_store_dwordx4 v[172:175], v2, s[28:31], s59 offen offset:3072 sc1
    v_mul_f32 v158, 0x3e8b97f6, v158
    v_pk_mul_f32 v[48:49], v[48:49], v[158:159] op_sel_hi:[1,0]
    v_pk_mul_f32 v[50:51], v[50:51], v[158:159] op_sel_hi:[1,0]
    v_pk_mul_f32 v[52:53], v[52:53], v[158:159] op_sel_hi:[1,0]
    v_pk_mul_f32 v[54:55], v[54:55], v[158:159] op_sel_hi:[1,0]
    v_pk_mul_f32 v[56:57], v[56:57], v[158:159] op_sel_hi:[1,0]
    v_pk_mul_f32 v[58:59], v[58:59], v[158:159] op_sel_hi:[1,0]
    v_pk_mul_f32 v[60:61], v[60:61], v[158:159] op_sel_hi:[1,0]
    v_pk_mul_f32 v[62:63], v[62:63], v[158:159] op_sel_hi:[1,0]
    v_cvt_pk_bf16_f32 v128, v48, v49
    v_cvt_pk_bf16_f32 v129, v50, v51
    v_cvt_pk_bf16_f32 v130, v52, v53
    v_cvt_pk_bf16_f32 v131, v54, v55
    v_cvt_pk_bf16_f32 v132, v56, v57
    v_cvt_pk_bf16_f32 v133, v58, v59
    v_cvt_pk_bf16_f32 v134, v60, v61
    v_cvt_pk_bf16_f32 v135, v62, v63
    v_cndmask_b32 v134, v134, v187, s[60:61]
    v_cndmask_b32 v135, v135, v187, s[60:61]
    v_mfma_f32_32x32x16_bf16 v[48:63], v[160:163], v[128:131], 0
    s_nop 0
    v_mfma_f32_32x32x16_bf16 v[48:63], v[164:167], v[132:135], v[48:63]
    s_lshl_b32 s56, s3, 11
    s_add_u32 s56, s56, 147456
    v_add_u32 v152, s56, v2
    ds_write_b128 v152, v[128:131]
    s_nop 7
    v_max3_f32 v48, v48, v49, v50
    v_max3_f32 v48, v48, v51, v52
    v_max3_f32 v48, v48, v53, v54
    v_max3_f32 v48, v48, v55, v56
    v_max3_f32 v48, v48, v57, v58
    v_max3_f32 v48, v48, v59, v60
    v_max3_f32 v48, v48, v61, v62
    v_max_f32 v48, v48, v63
    v_mov_b32 v49, v48
    s_nop 1
    v_permlane32_swap_b32 v48, v49
    v_max_f32 v48, v48, v49
    v_cvt_pk_bf16_f32 v48, -v48, 0
    v_cndmask_b32 v134, v134, v48, s[60:61]
    ds_write_b128 v152, v[132:135] offset:1024
    s_waitcnt vmcnt(0)
    s_mov_b32 s74, 0x400000
L_nonce_1:
    v_readfirstlane_b32 s54, v234
    v_readfirstlane_b32 s55, v235
    s_cmp_lg_u32 s54, 0
    s_cbranch_scc1 L_nonceok_2
    s_sub_u32 s74, s74, 1
    s_cbranch_scc1 L_nonceok_2
    buffer_load_dwordx2 v[234:235], v187, s[36:39], 0 offen sc1
    s_waitcnt vmcnt(0)
    s_branch L_nonce_1
L_nonceok_2:
    s_mov_b64 exec, 1
    buffer_store_dwordx2 v[234:235], v41, s[28:31], s58 offen
    s_mov_b32 s80, s58
    s_mov_b64 exec, -1
    s_nop 0
    s_waitcnt lgkmcnt(0)
    s_barrier
    s_xor_b32 s56, s3, 0
    s_lshl_b32 s56, s56, 11
    s_add_u32 s56, s56, 147456
    v_add_u32 v152, s56, v2
    ds_read_b128 v[16:19], v152
    ds_read_b128 v[20:23], v152 offset:1024
    s_xor_b32 s56, s3, 1
    s_lshl_b32 s56, s56, 11
    s_add_u32 s56, s56, 147456
    v_add_u32_e64 v153, s56, v2
    ds_read_b128 v[24:27], v153
    ds_read_b128 v[28:31], v153 offset:1024
    s_xor_b32 s56, s3, 2
    s_lshl_b32 s56, s56, 11
    s_add_u32 s56, s56, 147456
    v_add_u32_e64 v154, s56, v2
    ds_read_b128 v[32:35], v154
    ds_read_b128 v[36:39], v154 offset:1024
    s_xor_b32 s56, s3, 3
    s_lshl_b32 s56, s56, 11
    s_add_u32 s56, s56, 147456
    v_add_u32_e64 v155, s56, v2
    ds_read_b128 v[40:43], v155
    ds_read_b128 v[44:47], v155 offset:1024
    s_cmp_ge_u32 s2, 224
    s_cselect_b32 s18, 0, s18
    s_cselect_b32 s26, 0, s26
    s_cselect_b32 s22, 0, s22
    s_andn2_b32 s56, s76, 0x780
    v_add_u32_e64 v155, s56, v9
    s_waitcnt lgkmcnt(0)
    v_mfma_f32_32x32x16_bf16 v[112:127], v[160:163], v[16:19], 0
    v_mfma_f32_32x32x16_bf16 v[112:127], v[164:167], v[20:23], v[112:127]
    v_add_u32 v152, 6144, v4
    v_add_u32 v153, 12288, v4
    v_add_u32 v154, 18432, v4
    v_mfma_f32_32x32x16_bf16 v[128:143], v[160:163], v[24:27], 0
    s_nop 7
    v_exp_f32 v112, v112
    v_exp_f32 v113, v113
    v_exp_f32 v114, v114
    v_exp_f32 v115, v115
    v_exp_f32 v116, v116
    v_exp_f32 v117, v117
    v_exp_f32 v118, v118
    v_exp_f32_e64 v119, v119
    v_cvt_pk_bf16_f32 v144, v112, v113
    v_cvt_pk_bf16_f32 v145, v114, v115
    v_cvt_pk_bf16_f32 v146, v116, v117
    v_cvt_pk_bf16_f32 v147, v118, v119
    v_mfma_f32_32x32x16_bf16 v[128:143], v[164:167], v[28:31], v[128:143]
    v_exp_f32 v120, v120
    v_exp_f32 v121, v121
    v_exp_f32 v122, v122
    v_exp_f32 v123, v123
    v_exp_f32_e64 v124, v124
    v_mfma_f32_32x32x16_bf16 v[48:63], v[168:171], v[144:147], 0
    v_exp_f32 v125, v125
    v_exp_f32 v126, v126
    v_exp_f32_e64 v127, v127
    v_cvt_pk_bf16_f32 v148, v120, v121
    v_cvt_pk_bf16_f32 v149, v122, v123
    v_cvt_pk_bf16_f32 v150, v124, v125
    v_cvt_pk_bf16_f32 v151, v126, v127
    s_barrier
    s_mov_b32 exec_lo, 0xffff
    s_mov_b32 exec_hi, 0
    s_mov_b32 s56, 0x0
    s_mov_b32 s74, 30
L_poll_3:
    buffer_load_dwordx2 v[156:157], v155, s[28:31], s56 offen sc1
    s_waitcnt vmcnt(0)
    v_cmp_ne_u64 vcc, s[54:55], v[156:157]
    s_cbranch_vccz L_pollok_4
    s_sub_u32 s74, s74, 1
    s_cbranch_scc0 L_poll_3
    s_mov_b64 exec, 1
    v_mov_b32 v252, s54
    v_mov_b32 v253, s55
    v_mov_b32_e64 v254, 0
    buffer_store_dwordx2 v[252:253], v254, s[28:31], s80 offen sc1
    s_mov_b32 s80, 0x7ffffff0
    s_mov_b32 exec_lo, 0xffff
    s_mov_b32 exec_hi, 0xffff
    s_mov_b32 s74, 0x400000
L_pollg_5:
    buffer_load_dwordx2 v[156:157], v155, s[28:31], s56 offen sc1
    s_sub_u32 s74, s74, 1
    s_cbranch_scc1 L_pollok_4
    s_waitcnt vmcnt(0)
    v_cmp_eq_u64 vcc, s[54:55], v[156:157]
    s_nop 0
    s_or_b32 vcc_lo, vcc_lo, vcc_hi
    s_cmp_lg_u32 vcc_lo, 0xffff
    s_cbranch_scc1 L_pollg_5
L_pollok_4:
    s_waitcnt vmcnt(0)
    s_mov_b64 exec, -1
    s_add_u32 s69, s69, 16384
    s_bitset0_b32 s69, 18
    buffer_load_dwordx4 v[176:179], v2, s[28:31], s69 offen offset:0 sc1
    buffer_load_dwordx4 v[180:183], v2, s[28:31], s69 offen offset:1024 sc1
    buffer_load_dwordx4 v[184:187], v2, s[28:31], s69 offen offset:2048 sc1
    buffer_load_dwordx4 v[188:191], v2, s[28:31], s69 offen offset:3072 sc1
    s_add_u32 s69, s69, 16384
    s_bitset0_b32 s69, 18
    buffer_load_dwordx4 v[192:195], v2, s[28:31], s69 offen offset:0 sc1
    buffer_load_dwordx4 v[196:199], v2, s[28:31], s69 offen offset:1024 sc1
    buffer_load_dwordx4 v[200:203], v2, s[28:31], s69 offen offset:2048 sc1
    buffer_load_dwordx4 v[204:207], v2, s[28:31], s69 offen offset:3072 sc1
    s_mov_b64 exec, 1
    v_mov_b32 v252, s54
    v_mov_b32 v253, s55
    v_mov_b32_e64 v254, 0
    buffer_store_dwordx2 v[252:253], v254, s[28:31], s80 offen sc1
    s_mov_b32 s80, 0x7ffffff0
    s_mov_b64 exec, -1
    v_mfma_f32_32x32x16_bf16 v[112:127], v[160:163], v[32:35], 0
    s_add_u32 m0, s70, 0
    v_exp_f32 v128, v128
    v_exp_f32 v129, v129
    v_exp_f32 v130, v130
    v_exp_f32 v131, v131
    v_exp_f32_e64 v132, v132
    v_mfma_f32_32x32x16_bf16 v[48:63], v[172:175], v[148:151], v[48:63]
    s_add_u32 s58, s72, 0
    v_exp_f32 v133, v133
    v_exp_f32 v134, v134
    v_exp_f32 v135, v135
    v_cvt_pk_bf16_f32 v144, v128, v129
    v_cvt_pk_bf16_f32 v145, v130, v131
    v_cvt_pk_bf16_f32 v146, v132, v133
    v_cvt_pk_bf16_f32 v147, v134, v135
    v_mfma_f32_32x32x16_bf16 v[112:127], v[164:167], v[36:39], v[112:127]
    v_exp_f32 v136, v136
    v_exp_f32 v137, v137
    v_exp_f32 v138, v138
    v_exp_f32 v139, v139
    v_exp_f32_e64 v140, v140
    v_mfma_f32_32x32x16_bf16 v[64:79], v[168:171], v[144:147], 0
    v_exp_f32 v141, v141
    v_exp_f32 v142, v142
    v_exp_f32_e64 v143, v143
    v_cvt_pk_bf16_f32 v148, v136, v137
    v_cvt_pk_bf16_f32 v149, v138, v139
    v_cvt_pk_bf16_f32 v150, v140, v141
    v_cvt_pk_bf16_f32 v151, v142, v143
    v_mfma_f32_32x32x16_bf16 v[128:143], v[160:163], v[40:43], 0
    v_exp_f32 v112, v112
    v_exp_f32 v113, v113
    v_exp_f32 v114, v114
    v_exp_f32 v115, v115
    v_exp_f32_e64 v116, v116
    v_mfma_f32_32x32x16_bf16 v[64:79], v[172:175], v[148:151], v[64:79]
    v_exp_f32 v117, v117
    v_exp_f32 v118, v118
    v_exp_f32_e64 v119, v119
    v_cvt_pk_bf16_f32 v144, v112, v113
    v_cvt_pk_bf16_f32 v145, v114, v115
    v_cvt_pk_bf16_f32 v146, v116, v117
    v_cvt_pk_bf16_f32 v147, v118, v119
    v_mfma_f32_32x32x16_bf16 v[128:143], v[164:167], v[44:47], v[128:143]
    s_add_u32 s69, s69, 16384
    s_bitset0_b32 s69, 18
    buffer_load_dwordx4 v[160:163], v2, s[28:31], s69 offen offset:0 sc1
    buffer_load_dwordx4 v[164:167], v2, s[28:31], s69 offen offset:1024 sc1
    v_exp_f32 v120, v120
    v_exp_f32 v121, v121
    v_exp_f32 v122, v122
    v_exp_f32 v123, v123
    v_exp_f32 v124, v124
    v_mfma_f32_32x32x16_bf16 v[80:95], v[168:171], v[144:147], 0
    v_exp_f32 v125, v125
    v_exp_f32 v126, v126
    v_exp_f32_e64 v127, v127
    v_cvt_pk_bf16_f32 v148, v120, v121
    v_cvt_pk_bf16_f32 v149, v122, v123
    v_cvt_pk_bf16_f32 v150, v124, v125
    v_cvt_pk_bf16_f32 v151, v126, v127
    s_waitcnt vmcnt(9)
    v_mfma_f32_32x32x16_bf16 v[112:127], v[176:179], v[16:19], 0
    v_exp_f32 v128, v128
    v_exp_f32 v129, v129
    v_exp_f32 v130, v130
    v_exp_f32 v131, v131
    v_exp_f32 v132, v132
    v_mfma_f32_32x32x16_bf16 v[80:95], v[172:175], v[148:151], v[80:95]
    v_exp_f32 v133, v133
    v_exp_f32 v134, v134
    v_exp_f32_e64 v135, v135
    v_cvt_pk_bf16_f32 v144, v128, v129
    v_cvt_pk_bf16_f32 v145, v130, v131
    v_cvt_pk_bf16_f32 v146, v132, v133
    v_cvt_pk_bf16_f32 v147, v134, v135
    v_mfma_f32_32x32x16_bf16 v[112:127], v[180:183], v[20:23], v[112:127]
    v_exp_f32 v136, v136
    v_exp_f32 v137, v137
    v_exp_f32 v138, v138
    v_exp_f32 v139, v139
    v_exp_f32_e64 v140, v140
    v_mfma_f32_32x32x16_bf16 v[96:111], v[168:171], v[144:147], 0
    v_exp_f32 v141, v141
    v_exp_f32 v142, v142
    v_exp_f32_e64 v143, v143
    v_cvt_pk_bf16_f32 v148, v136, v137
    v_cvt_pk_bf16_f32 v149, v138, v139
    v_cvt_pk_bf16_f32 v150, v140, v141
    v_cvt_pk_bf16_f32 v151, v142, v143
    v_mfma_f32_32x32x16_bf16 v[128:143], v[176:179], v[24:27], 0
    buffer_load_dwordx4 v4, s[16:19], s58 offen offset:0 lds
    v_exp_f32 v112, v112
    v_exp_f32 v113, v113
    v_exp_f32 v114, v114
    v_exp_f32 v115, v115
    v_exp_f32_e64 v116, v116
    v_mfma_f32_32x32x16_bf16 v[96:111], v[172:175], v[148:151], v[96:111]
    buffer_load_dwordx4 v[168:171], v2, s[28:31], s69 offen offset:2048 sc1
    buffer_load_dwordx4 v[172:175], v2, s[28:31], s69 offen offset:3072 sc1
    v_exp_f32 v117, v117
    v_exp_f32 v118, v118
    v_exp_f32_e64 v119, v119
    v_cvt_pk_bf16_f32 v144, v112, v113
    v_cvt_pk_bf16_f32 v145, v114, v115
    v_cvt_pk_bf16_f32 v146, v116, v117
    v_cvt_pk_bf16_f32 v147, v118, v119
    v_mfma_f32_32x32x16_bf16 v[128:143], v[180:183], v[28:31], v[128:143]
    buffer_load_dwordx4 v152, s[16:19], s58 offen offset:1024 lds
    v_exp_f32 v120, v120
    v_exp_f32 v121, v121
    v_exp_f32 v122, v122
    v_exp_f32 v123, v123
    v_exp_f32 v124, v124
    s_waitcnt vmcnt(11)
    v_mfma_f32_32x32x16_bf16 v[48:63], v[184:187], v[144:147], v[48:63]
    buffer_load_dwordx4 v153, s[16:19], s58 offen offset:2048 lds
    v_exp_f32 v125, v125
    v_exp_f32 v126, v126
    v_exp_f32_e64 v127, v127
    v_cvt_pk_bf16_f32 v148, v120, v121
    v_cvt_pk_bf16_f32 v149, v122, v123
    v_cvt_pk_bf16_f32 v150, v124, v125
    v_cvt_pk_bf16_f32 v151, v126, v127
    v_mfma_f32_32x32x16_bf16 v[112:127], v[176:179], v[32:35], 0
    buffer_load_dwordx4 v154, s[16:19], s58 offen offset:3072 lds
    v_exp_f32 v128, v128
    v_exp_f32 v129, v129
    v_exp_f32 v130, v130
    v_exp_f32 v131, v131
    v_exp_f32_e64 v132, v132
    v_mfma_f32_32x32x16_bf16 v[48:63], v[188:191], v[148:151], v[48:63]
    s_add_u32 m0, s70, 4096
    v_exp_f32 v133, v133
    v_exp_f32 v134, v134
    v_exp_f32_e64 v135, v135
    v_cvt_pk_bf16_f32 v144, v128, v129
    v_cvt_pk_bf16_f32 v145, v130, v131
    v_cvt_pk_bf16_f32 v146, v132, v133
    v_cvt_pk_bf16_f32 v147, v134, v135
    v_mfma_f32_32x32x16_bf16 v[112:127], v[180:183], v[36:39], v[112:127]
    s_add_u32 s58, s72, 25088
    v_exp_f32 v136, v136
    v_exp_f32 v137, v137
    v_exp_f32 v138, v138
    v_exp_f32 v139, v139
    v_exp_f32_e64 v140, v140
    v_mfma_f32_32x32x16_bf16 v[64:79], v[184:187], v[144:147], v[64:79]
    buffer_load_dwordx4 v4, s[16:19], s58 offen offset:0 lds
    v_exp_f32 v141, v141
    v_exp_f32 v142, v142
    v_exp_f32_e64 v143, v143
    v_cvt_pk_bf16_f32 v148, v136, v137
    v_cvt_pk_bf16_f32 v149, v138, v139
    v_cvt_pk_bf16_f32 v150, v140, v141
    v_cvt_pk_bf16_f32 v151, v142, v143
    v_mfma_f32_32x32x16_bf16 v[128:143], v[176:179], v[40:43], 0
    buffer_load_dwordx4 v152, s[16:19], s58 offen offset:1024 lds
    v_exp_f32 v112, v112
    v_exp_f32 v113, v113
    v_exp_f32 v114, v114
    v_exp_f32 v115, v115
    v_exp_f32_e64 v116, v116
    v_mfma_f32_32x32x16_bf16 v[64:79], v[188:191], v[148:151], v[64:79]
    v_exp_f32 v117, v117
    v_exp_f32 v118, v118
    v_exp_f32_e64 v119, v119
    v_cvt_pk_bf16_f32 v144, v112, v113
    v_cvt_pk_bf16_f32 v145, v114, v115
    v_cvt_pk_bf16_f32 v146, v116, v117
    v_cvt_pk_bf16_f32 v147, v118, v119
    v_mfma_f32_32x32x16_bf16 v[128:143], v[180:183], v[44:47], v[128:143]
    s_add_u32 s69, s69, 16384
    s_bitset0_b32 s69, 18
    buffer_load_dwordx4 v[176:179], v2, s[28:31], s69 offen offset:0 sc1
    buffer_load_dwordx4 v[180:183], v2, s[28:31], s69 offen offset:1024 sc1
    v_exp_f32 v120, v120
    v_exp_f32 v121, v121
    v_exp_f32 v122, v122
    v_exp_f32 v123, v123
    v_exp_f32 v124, v124
    v_mfma_f32_32x32x16_bf16 v[80:95], v[184:187], v[144:147], v[80:95]
    buffer_load_dwordx4 v153, s[16:19], s58 offen offset:2048 lds
    v_exp_f32 v125, v125
    v_exp_f32 v126, v126
    v_exp_f32_e64 v127, v127
    v_cvt_pk_bf16_f32 v148, v120, v121
    v_cvt_pk_bf16_f32 v149, v122, v123
    v_cvt_pk_bf16_f32 v150, v124, v125
    v_cvt_pk_bf16_f32 v151, v126, v127
    s_waitcnt vmcnt(16)
    v_mfma_f32_32x32x16_bf16 v[112:127], v[192:195], v[16:19], 0
    buffer_load_dwordx4 v154, s[16:19], s58 offen offset:3072 lds
    v_exp_f32 v128, v128
    v_exp_f32 v129, v129
    v_exp_f32 v130, v130
    v_exp_f32 v131, v131
    v_exp_f32 v132, v132
    v_mfma_f32_32x32x16_bf16 v[80:95], v[188:191], v[148:151], v[80:95]
    s_add_u32 m0, s70, 8192
    v_exp_f32 v133, v133
    v_exp_f32 v134, v134
    v_exp_f32_e64 v135, v135
    v_cvt_pk_bf16_f32 v144, v128, v129
    v_cvt_pk_bf16_f32 v145, v130, v131
    v_cvt_pk_bf16_f32 v146, v132, v133
    v_cvt_pk_bf16_f32 v147, v134, v135
    v_mfma_f32_32x32x16_bf16 v[112:127], v[196:199], v[20:23], v[112:127]
    s_add_u32 s58, s72, 50176
    v_exp_f32 v136, v136
    v_exp_f32 v137, v137
    v_exp_f32 v138, v138
    v_exp_f32 v139, v139
    v_exp_f32_e64 v140, v140
    v_mfma_f32_32x32x16_bf16 v[96:111], v[184:187], v[144:147], v[96:111]
    buffer_load_dwordx4 v4, s[16:19], s58 offen offset:0 lds
    v_exp_f32 v141, v141
    v_exp_f32 v142, v142
    v_exp_f32_e64 v143, v143
    v_cvt_pk_bf16_f32 v148, v136, v137
    v_cvt_pk_bf16_f32 v149, v138, v139
    v_cvt_pk_bf16_f32 v150, v140, v141
    v_cvt_pk_bf16_f32 v151, v142, v143
    v_mfma_f32_32x32x16_bf16 v[128:143], v[192:195], v[24:27], 0
    buffer_load_dwordx4 v152, s[16:19], s58 offen offset:1024 lds
    v_exp_f32 v112, v112
    v_exp_f32 v113, v113
    v_exp_f32 v114, v114
    v_exp_f32 v115, v115
    v_exp_f32_e64 v116, v116
    v_mfma_f32_32x32x16_bf16 v[96:111], v[188:191], v[148:151], v[96:111]
    buffer_load_dwordx4 v[184:187], v2, s[28:31], s69 offen offset:2048 sc1
    buffer_load_dwordx4 v[188:191], v2, s[28:31], s69 offen offset:3072 sc1
    v_exp_f32 v117, v117
    v_exp_f32 v118, v118
    v_exp_f32_e64 v119, v119
    v_cvt_pk_bf16_f32 v144, v112, v113
    v_cvt_pk_bf16_f32 v145, v114, v115
    v_cvt_pk_bf16_f32 v146, v116, v117
    v_cvt_pk_bf16_f32 v147, v118, v119
    v_mfma_f32_32x32x16_bf16 v[128:143], v[196:199], v[28:31], v[128:143]
    buffer_load_dwordx4 v153, s[16:19], s58 offen offset:2048 lds
    v_exp_f32 v120, v120
    v_exp_f32 v121, v121
    v_exp_f32 v122, v122
    v_exp_f32 v123, v123
    v_exp_f32 v124, v124
    s_waitcnt vmcnt(20)
    v_mfma_f32_32x32x16_bf16 v[48:63], v[200:203], v[144:147], v[48:63]
    v_exp_f32 v125, v125
    v_exp_f32 v126, v126
    v_exp_f32_e64 v127, v127
    v_cvt_pk_bf16_f32 v148, v120, v121
    v_cvt_pk_bf16_f32 v149, v122, v123
    v_cvt_pk_bf16_f32 v150, v124, v125
    v_cvt_pk_bf16_f32 v151, v126, v127
    v_mfma_f32_32x32x16_bf16 v[112:127], v[192:195], v[32:35], 0
    buffer_load_dwordx4 v154, s[16:19], s58 offen offset:3072 lds
    v_exp_f32 v128, v128
    v_exp_f32 v129, v129
    v_exp_f32 v130, v130
    v_exp_f32 v131, v131
    v_exp_f32_e64 v132, v132
    v_mfma_f32_32x32x16_bf16 v[48:63], v[204:207], v[148:151], v[48:63]
    s_add_u32 m0, s67, 0
    v_exp_f32 v133, v133
    v_exp_f32 v134, v134
    v_exp_f32 v135, v135
    v_cvt_pk_bf16_f32 v144, v128, v129
    v_cvt_pk_bf16_f32 v145, v130, v131
    v_cvt_pk_bf16_f32 v146, v132, v133
    v_cvt_pk_bf16_f32 v147, v134, v135
    v_mfma_f32_32x32x16_bf16 v[112:127], v[196:199], v[36:39], v[112:127]
    s_add_u32 s58, s72, 75264
    v_exp_f32 v136, v136
    v_exp_f32 v137, v137
    v_exp_f32 v138, v138
    v_exp_f32 v139, v139
    v_exp_f32_e64 v140, v140
    v_mfma_f32_32x32x16_bf16 v[64:79], v[200:203], v[144:147], v[64:79]
    buffer_load_dwordx4 v4, s[16:19], s58 offen offset:0 lds
    v_exp_f32 v141, v141
    v_exp_f32 v142, v142
    v_exp_f32_e64 v143, v143
    v_cvt_pk_bf16_f32 v148, v136, v137
    v_cvt_pk_bf16_f32 v149, v138, v139
    v_cvt_pk_bf16_f32 v150, v140, v141
    v_cvt_pk_bf16_f32 v151, v142, v143
    v_mfma_f32_32x32x16_bf16 v[128:143], v[192:195], v[40:43], 0
    buffer_load_dwordx4 v152, s[16:19], s58 offen offset:1024 lds
    v_exp_f32 v112, v112
    v_exp_f32 v113, v113
    v_exp_f32 v114, v114
    v_exp_f32 v115, v115
    v_exp_f32_e64 v116, v116
    v_mfma_f32_32x32x16_bf16 v[64:79], v[204:207], v[148:151], v[64:79]
    v_exp_f32 v117, v117
    v_exp_f32 v118, v118
    v_exp_f32_e64 v119, v119
    v_cvt_pk_bf16_f32 v144, v112, v113
    v_cvt_pk_bf16_f32 v145, v114, v115
    v_cvt_pk_bf16_f32 v146, v116, v117
    v_cvt_pk_bf16_f32 v147, v118, v119
    v_mfma_f32_32x32x16_bf16 v[128:143], v[196:199], v[44:47], v[128:143]
    s_add_u32 s69, s69, 16384
    s_bitset0_b32 s69, 18
    buffer_load_dwordx4 v[192:195], v2, s[28:31], s69 offen offset:0 sc1
    buffer_load_dwordx4 v[196:199], v2, s[28:31], s69 offen offset:1024 sc1
    v_exp_f32 v120, v120
    v_exp_f32 v121, v121
    v_exp_f32 v122, v122
    v_exp_f32 v123, v123
    v_exp_f32 v124, v124
    v_mfma_f32_32x32x16_bf16 v[80:95], v[200:203], v[144:147], v[80:95]
    buffer_load_dwordx4 v153, s[16:19], s58 offen offset:2048 lds
    v_exp_f32 v125, v125
    v_exp_f32 v126, v126
    v_exp_f32_e64 v127, v127
    v_cvt_pk_bf16_f32 v148, v120, v121
    v_cvt_pk_bf16_f32 v149, v122, v123
    v_cvt_pk_bf16_f32 v150, v124, v125
    v_cvt_pk_bf16_f32 v151, v126, v127
    s_waitcnt vmcnt(23)
    v_mfma_f32_32x32x16_bf16 v[112:127], v[160:163], v[16:19], 0
    buffer_load_dwordx4 v154, s[16:19], s58 offen offset:3072 lds
    v_exp_f32 v128, v128
    v_exp_f32 v129, v129
    v_exp_f32 v130, v130
    v_exp_f32 v131, v131
    v_exp_f32 v132, v132
    v_mfma_f32_32x32x16_bf16 v[80:95], v[204:207], v[148:151], v[80:95]
    s_add_u32 m0, s67, 4096
    v_exp_f32 v133, v133
    v_exp_f32 v134, v134
    v_exp_f32_e64 v135, v135
    v_cvt_pk_bf16_f32 v144, v128, v129
    v_cvt_pk_bf16_f32 v145, v130, v131
    v_cvt_pk_bf16_f32 v146, v132, v133
    v_cvt_pk_bf16_f32 v147, v134, v135
    v_mfma_f32_32x32x16_bf16 v[112:127], v[164:167], v[20:23], v[112:127]
    s_add_u32 s58, s91, 0
    v_exp_f32 v136, v136
    v_exp_f32 v137, v137
    v_exp_f32 v138, v138
    v_exp_f32 v139, v139
    v_exp_f32 v140, v140
    v_mfma_f32_32x32x16_bf16 v[96:111], v[200:203], v[144:147], v[96:111]
    buffer_load_dwordx4 v4, s[24:27], s58 offen offset:0 lds
    v_exp_f32 v141, v141
    v_exp_f32 v142, v142
    v_exp_f32_e64 v143, v143
    v_cvt_pk_bf16_f32 v148, v136, v137
    v_cvt_pk_bf16_f32 v149, v138, v139
    v_cvt_pk_bf16_f32 v150, v140, v141
    v_cvt_pk_bf16_f32 v151, v142, v143
    v_mfma_f32_32x32x16_bf16 v[128:143], v[160:163], v[24:27], 0
    buffer_load_dwordx4 v152, s[24:27], s58 offen offset:1024 lds
    v_exp_f32 v112, v112
    v_exp_f32 v113, v113
    v_exp_f32 v114, v114
    v_exp_f32 v115, v115
    v_exp_f32_e64 v116, v116
    v_mfma_f32_32x32x16_bf16 v[96:111], v[204:207], v[148:151], v[96:111]
    buffer_load_dwordx4 v[200:203], v2, s[28:31], s69 offen offset:2048 sc1
    buffer_load_dwordx4 v[204:207], v2, s[28:31], s69 offen offset:3072 sc1
    v_exp_f32 v117, v117
    v_exp_f32 v118, v118
    v_exp_f32_e64 v119, v119
    v_cvt_pk_bf16_f32 v144, v112, v113
    v_cvt_pk_bf16_f32 v145, v114, v115
    v_cvt_pk_bf16_f32 v146, v116, v117
    v_cvt_pk_bf16_f32 v147, v118, v119
    v_mfma_f32_32x32x16_bf16 v[128:143], v[164:167], v[28:31], v[128:143]
    s_waitcnt vmcnt(24)
    ds_read_b64_tr_b16 v[208:209], v7 offset:0
    ds_read_b64_tr_b16 v[210:211], v7 offset:1024
    ds_read_b64_tr_b16 v[212:213], v5 offset:0
    ds_read_b64_tr_b16 v[214:215], v5 offset:1024
    v_exp_f32 v120, v120
    v_exp_f32 v121, v121
    v_exp_f32 v122, v122
    v_exp_f32 v123, v123
    v_exp_f32 v124, v124
    v_mfma_f32_32x32x16_bf16 v[48:63], v[168:171], v[144:147], v[48:63]
    buffer_load_dwordx4 v153, s[24:27], s58 offen offset:2048 lds
    v_exp_f32 v125, v125
    v_exp_f32 v126, v126
    v_exp_f32_e64 v127, v127
    v_cvt_pk_bf16_f32 v148, v120, v121
    v_cvt_pk_bf16_f32 v149, v122, v123
    v_cvt_pk_bf16_f32 v150, v124, v125
    v_cvt_pk_bf16_f32 v151, v126, v127
    v_mfma_f32_32x32x16_bf16 v[112:127], v[160:163], v[32:35], 0
    s_waitcnt vmcnt(23) lgkmcnt(0)
    ds_read_b64_tr_b16 v[216:217], v7 offset:2048
    ds_read_b64_tr_b16 v[218:219], v7 offset:3072
    ds_read_b64_tr_b16 v[220:221], v5 offset:2048
    ds_read_b64_tr_b16 v[222:223], v5 offset:3072
    v_exp_f32 v128, v128
    v_exp_f32 v129, v129
    v_exp_f32 v130, v130
    v_exp_f32 v131, v131
    v_exp_f32 v132, v132
    v_mfma_f32_32x32x16_bf16 v[48:63], v[172:175], v[148:151], v[48:63]
    buffer_load_dwordx4 v154, s[24:27], s58 offen offset:3072 lds
    v_exp_f32 v133, v133
    v_exp_f32 v134, v134
    v_exp_f32_e64 v135, v135
    v_cvt_pk_bf16_f32 v144, v128, v129
    v_cvt_pk_bf16_f32 v145, v130, v131
    v_cvt_pk_bf16_f32 v146, v132, v133
    v_cvt_pk_bf16_f32 v147, v134, v135
    v_mfma_f32_32x32x16_bf16 v[112:127], v[164:167], v[36:39], v[112:127]
    s_add_u32 m0, s67, 8192
    v_exp_f32 v136, v136
    v_exp_f32 v137, v137
    v_exp_f32 v138, v138
    v_exp_f32 v139, v139
    v_exp_f32_e64 v140, v140
    v_mfma_f32_32x32x16_bf16 v[64:79], v[168:171], v[144:147], v[64:79]
    s_add_u32 s58, s91, 28672
    v_exp_f32 v141, v141
    v_exp_f32 v142, v142
    v_exp_f32_e64 v143, v143
    v_cvt_pk_bf16_f32 v148, v136, v137
    v_cvt_pk_bf16_f32 v149, v138, v139
    v_cvt_pk_bf16_f32 v150, v140, v141
    v_cvt_pk_bf16_f32 v151, v142, v143
    v_mfma_f32_32x32x16_bf16 v[128:143], v[160:163], v[40:43], 0
    buffer_load_dwordx4 v4, s[24:27], s58 offen offset:0 lds
    v_exp_f32 v112, v112
    v_exp_f32 v113, v113
    v_exp_f32 v114, v114
    v_exp_f32 v115, v115
    v_exp_f32_e64 v116, v116
    v_mfma_f32_32x32x16_bf16 v[64:79], v[172:175], v[148:151], v[64:79]
    buffer_load_dwordx4 v152, s[24:27], s58 offen offset:1024 lds
    v_exp_f32 v117, v117
    v_exp_f32 v118, v118
    v_exp_f32_e64 v119, v119
    v_cvt_pk_bf16_f32 v144, v112, v113
    v_cvt_pk_bf16_f32 v145, v114, v115
    v_cvt_pk_bf16_f32 v146, v116, v117
    v_cvt_pk_bf16_f32 v147, v118, v119
    v_mfma_f32_32x32x16_bf16 v[128:143], v[164:167], v[44:47], v[128:143]
    s_add_u32 s69, s69, 16384
    s_bitset0_b32 s69, 18
    buffer_load_dwordx4 v[160:163], v2, s[28:31], s69 offen offset:0 sc1
    buffer_load_dwordx4 v[164:167], v2, s[28:31], s69 offen offset:1024 sc1
    v_exp_f32 v120, v120
    v_exp_f32 v121, v121
    v_exp_f32 v122, v122
    v_exp_f32 v123, v123
    v_exp_f32 v124, v124
    v_mfma_f32_32x32x16_bf16 v[80:95], v[168:171], v[144:147], v[80:95]
    s_waitcnt vmcnt(26) lgkmcnt(0)
    ds_read_b64_tr_b16 v[224:225], v7 offset:4096
    ds_read_b64_tr_b16 v[226:227], v7 offset:5120
    ds_read_b64_tr_b16 v[228:229], v5 offset:4096
    ds_read_b64_tr_b16 v[230:231], v5 offset:5120
    v_exp_f32 v125, v125
    v_exp_f32 v126, v126
    v_exp_f32 v127, v127
    v_cvt_pk_bf16_f32 v148, v120, v121
    v_cvt_pk_bf16_f32 v149, v122, v123
    v_cvt_pk_bf16_f32 v150, v124, v125
    v_cvt_pk_bf16_f32 v151, v126, v127
    s_waitcnt vmcnt(24)
    v_mfma_f32_32x32x16_bf16 v[112:127], v[176:179], v[16:19], 0
    buffer_load_dwordx4 v153, s[24:27], s58 offen offset:2048 lds
    v_exp_f32 v128, v128
    v_exp_f32 v129, v129
    v_exp_f32 v130, v130
    v_exp_f32 v131, v131
    v_exp_f32 v132, v132
    v_mfma_f32_32x32x16_bf16 v[80:95], v[172:175], v[148:151], v[80:95]
    buffer_load_dwordx4 v154, s[24:27], s58 offen offset:3072 lds
    v_exp_f32 v133, v133
    v_exp_f32 v134, v134
    v_exp_f32_e64 v135, v135
    v_cvt_pk_bf16_f32 v144, v128, v129
    v_cvt_pk_bf16_f32 v145, v130, v131
    v_cvt_pk_bf16_f32 v146, v132, v133
    v_cvt_pk_bf16_f32 v147, v134, v135
    v_mfma_f32_32x32x16_bf16 v[112:127], v[180:183], v[20:23], v[112:127]
    s_add_u32 m0, s67, 12288
    v_exp_f32 v136, v136
    v_exp_f32 v137, v137
    v_exp_f32 v138, v138
    v_exp_f32 v139, v139
    v_exp_f32_e64 v140, v140
    v_mfma_f32_32x32x16_bf16 v[96:111], v[168:171], v[144:147], v[96:111]
    s_waitcnt vmcnt(24) lgkmcnt(0)
    ds_read_b64_tr_b16 v[232:233], v7 offset:6144
    ds_read_b64_tr_b16 v[234:235], v7 offset:7168
    ds_read_b64_tr_b16 v[236:237], v5 offset:6144
    ds_read_b64_tr_b16 v[238:239], v5 offset:7168
    v_exp_f32 v141, v141
    v_exp_f32 v142, v142
    v_exp_f32 v143, v143
    v_cvt_pk_bf16_f32 v148, v136, v137
    v_cvt_pk_bf16_f32 v149, v138, v139
    v_cvt_pk_bf16_f32 v150, v140, v141
    v_cvt_pk_bf16_f32 v151, v142, v143
    v_mfma_f32_32x32x16_bf16 v[128:143], v[176:179], v[24:27], 0
    s_add_u32 s58, s92, 0
    v_exp_f32 v112, v112
    v_exp_f32 v113, v113
    v_exp_f32 v114, v114
    v_exp_f32 v115, v115
    v_exp_f32 v116, v116
    v_mfma_f32_32x32x16_bf16 v[96:111], v[172:175], v[148:151], v[96:111]
    buffer_load_dwordx4 v[168:171], v2, s[28:31], s69 offen offset:2048 sc1
    buffer_load_dwordx4 v[172:175], v2, s[28:31], s69 offen offset:3072 sc1
    v_exp_f32 v117, v117
    v_exp_f32 v118, v118
    v_exp_f32_e64 v119, v119
    v_cvt_pk_bf16_f32 v144, v112, v113
    v_cvt_pk_bf16_f32 v145, v114, v115
    v_cvt_pk_bf16_f32 v146, v116, v117
    v_cvt_pk_bf16_f32 v147, v118, v119
    v_mfma_f32_32x32x16_bf16 v[128:143], v[180:183], v[28:31], v[128:143]
    buffer_load_dwordx4 v4, s[24:27], s58 offen offset:0 lds
    v_exp_f32 v120, v120
    v_exp_f32 v121, v121
    v_exp_f32 v122, v122
    v_exp_f32 v123, v123
    v_exp_f32 v124, v124
    s_waitcnt vmcnt(23)
    v_mfma_f32_32x32x16_bf16 v[48:63], v[184:187], v[144:147], v[48:63]
    s_waitcnt lgkmcnt(0)
    ds_read_b64_tr_b16 a[224:225], v7 offset:8192
    ds_read_b64_tr_b16 a[226:227], v7 offset:9216
    ds_read_b64_tr_b16 a[228:229], v5 offset:8192
    ds_read_b64_tr_b16 a[230:231], v5 offset:9216
    v_exp_f32 v125, v125
    v_exp_f32 v126, v126
    v_exp_f32 v127, v127
    v_cvt_pk_bf16_f32 v148, v120, v121
    v_cvt_pk_bf16_f32 v149, v122, v123
    v_cvt_pk_bf16_f32 v150, v124, v125
    v_cvt_pk_bf16_f32 v151, v126, v127
    v_mfma_f32_32x32x16_bf16 v[112:127], v[176:179], v[32:35], 0
    buffer_load_dwordx4 v152, s[24:27], s58 offen offset:1024 lds
    v_exp_f32 v128, v128
    v_exp_f32 v129, v129
    v_exp_f32 v130, v130
    v_exp_f32 v131, v131
    v_exp_f32_e64 v132, v132
    v_mfma_f32_32x32x16_bf16 v[48:63], v[188:191], v[148:151], v[48:63]
    buffer_load_dwordx4 v153, s[24:27], s58 offen offset:2048 lds
    v_exp_f32 v133, v133
    v_exp_f32 v134, v134
    v_exp_f32_e64 v135, v135
    v_cvt_pk_bf16_f32 v144, v128, v129
    v_cvt_pk_bf16_f32 v145, v130, v131
    v_cvt_pk_bf16_f32 v146, v132, v133
    v_cvt_pk_bf16_f32 v147, v134, v135
    v_mfma_f32_32x32x16_bf16 v[112:127], v[180:183], v[36:39], v[112:127]
    buffer_load_dwordx4 v154, s[24:27], s58 offen offset:3072 lds
    v_exp_f32 v136, v136
    v_exp_f32 v137, v137
    v_exp_f32 v138, v138
    v_exp_f32 v139, v139
    v_exp_f32_e64 v140, v140
    v_mfma_f32_32x32x16_bf16 v[64:79], v[184:187], v[144:147], v[64:79]
    s_waitcnt vmcnt(24) lgkmcnt(0)
    ds_read_b64_tr_b16 a[232:233], v7 offset:10240
    ds_read_b64_tr_b16 a[234:235], v7 offset:11264
    ds_read_b64_tr_b16 a[236:237], v5 offset:10240
    ds_read_b64_tr_b16 a[238:239], v5 offset:11264
    v_exp_f32 v141, v141
    v_exp_f32 v142, v142
    v_exp_f32 v143, v143
    v_cvt_pk_bf16_f32 v148, v136, v137
    v_cvt_pk_bf16_f32 v149, v138, v139
    v_cvt_pk_bf16_f32 v150, v140, v141
    v_cvt_pk_bf16_f32 v151, v142, v143
    v_mfma_f32_32x32x16_bf16 v[128:143], v[176:179], v[40:43], 0
    s_add_u32 m0, s67, 16384
    v_exp_f32 v112, v112
    v_exp_f32 v113, v113
    v_exp_f32 v114, v114
    v_exp_f32 v115, v115
    v_exp_f32_e64 v116, v116
    v_mfma_f32_32x32x16_bf16 v[64:79], v[188:191], v[148:151], v[64:79]
    s_add_u32 s58, s92, 28672
    v_exp_f32 v117, v117
    v_exp_f32 v118, v118
    v_exp_f32_e64 v119, v119
    v_cvt_pk_bf16_f32 v144, v112, v113
    v_cvt_pk_bf16_f32 v145, v114, v115
    v_cvt_pk_bf16_f32 v146, v116, v117
    v_cvt_pk_bf16_f32 v147, v118, v119
    v_mfma_f32_32x32x16_bf16 v[128:143], v[180:183], v[44:47], v[128:143]
    s_add_u32 s69, s69, 16384
    s_bitset0_b32 s69, 18
    buffer_load_dwordx4 v[176:179], v2, s[28:31], s69 offen offset:0 sc1
    buffer_load_dwordx4 v[180:183], v2, s[28:31], s69 offen offset:1024 sc1
    v_exp_f32 v120, v120
    v_exp_f32 v121, v121
    v_exp_f32 v122, v122
    v_exp_f32 v123, v123
    v_exp_f32 v124, v124
    v_mfma_f32_32x32x16_bf16 v[80:95], v[184:187], v[144:147], v[80:95]
    s_waitcnt vmcnt(24) lgkmcnt(0)
    ds_read_b64_tr_b16 a[240:241], v3 offset:0
    ds_read_b64_tr_b16 a[242:243], v3 offset:1024
    ds_read_b64_tr_b16 a[244:245], v15 offset:0
    ds_read_b64_tr_b16 a[246:247], v15 offset:1024
    v_exp_f32 v125, v125
    v_exp_f32 v126, v126
    v_exp_f32 v127, v127
    v_cvt_pk_bf16_f32 v148, v120, v121
    v_cvt_pk_bf16_f32 v149, v122, v123
    v_cvt_pk_bf16_f32 v150, v124, v125
    v_cvt_pk_bf16_f32 v151, v126, v127
    s_waitcnt vmcnt(22)
    v_mfma_f32_32x32x16_bf16 v[112:127], v[192:195], v[16:19], 0
    buffer_load_dwordx4 v4, s[24:27], s58 offen offset:0 lds
    v_exp_f32 v128, v128
    v_exp_f32 v129, v129
    v_exp_f32 v130, v130
    v_exp_f32 v131, v131
    v_exp_f32 v132, v132
    v_mfma_f32_32x32x16_bf16 v[80:95], v[188:191], v[148:151], v[80:95]
    buffer_load_dwordx4 v152, s[24:27], s58 offen offset:1024 lds
    v_exp_f32 v133, v133
    v_exp_f32 v134, v134
    v_exp_f32_e64 v135, v135
    v_cvt_pk_bf16_f32 v144, v128, v129
    v_cvt_pk_bf16_f32 v145, v130, v131
    v_cvt_pk_bf16_f32 v146, v132, v133
    v_cvt_pk_bf16_f32 v147, v134, v135
    v_mfma_f32_32x32x16_bf16 v[112:127], v[196:199], v[20:23], v[112:127]
    buffer_load_dwordx4 v153, s[24:27], s58 offen offset:2048 lds
    v_exp_f32 v136, v136
    v_exp_f32 v137, v137
    v_exp_f32 v138, v138
    v_exp_f32 v139, v139
    v_exp_f32_e64 v140, v140
    v_mfma_f32_32x32x16_bf16 v[96:111], v[184:187], v[144:147], v[96:111]
    s_waitcnt vmcnt(23) lgkmcnt(0)
    ds_read_b64_tr_b16 a[248:249], v3 offset:2048
    ds_read_b64_tr_b16 a[250:251], v3 offset:3072
    ds_read_b64_tr_b16 a[252:253], v15 offset:2048
    ds_read_b64_tr_b16 a[254:255], v15 offset:3072
    v_exp_f32 v141, v141
    v_exp_f32 v142, v142
    v_exp_f32 v143, v143
    v_cvt_pk_bf16_f32 v148, v136, v137
    v_cvt_pk_bf16_f32 v149, v138, v139
    v_cvt_pk_bf16_f32 v150, v140, v141
    v_cvt_pk_bf16_f32 v151, v142, v143
    v_mfma_f32_32x32x16_bf16 v[128:143], v[192:195], v[24:27], 0
    buffer_load_dwordx4 v154, s[24:27], s58 offen offset:3072 lds
    v_exp_f32 v112, v112
    v_exp_f32 v113, v113
    v_exp_f32 v114, v114
    v_exp_f32 v115, v115
    v_exp_f32_e64 v116, v116
    v_mfma_f32_32x32x16_bf16 v[96:111], v[188:191], v[148:151], v[96:111]
    buffer_load_dwordx4 v[184:187], v2, s[28:31], s69 offen offset:2048 sc1
    buffer_load_dwordx4 v[188:191], v2, s[28:31], s69 offen offset:3072 sc1
    v_exp_f32 v117, v117
    v_exp_f32 v118, v118
    v_exp_f32_e64 v119, v119
    v_cvt_pk_bf16_f32 v144, v112, v113
    v_cvt_pk_bf16_f32 v145, v114, v115
    v_cvt_pk_bf16_f32 v146, v116, v117
    v_cvt_pk_bf16_f32 v147, v118, v119
    v_mfma_f32_32x32x16_bf16 v[128:143], v[196:199], v[28:31], v[128:143]
    s_add_u32 m0, s70, 0
    v_exp_f32 v120, v120
    v_exp_f32 v121, v121
    v_exp_f32 v122, v122
    v_exp_f32 v123, v123
    v_exp_f32_e64 v124, v124
    s_waitcnt vmcnt(22)
    v_mfma_f32_32x32x16_bf16 v[48:63], v[200:203], v[144:147], v[48:63]
    s_waitcnt lgkmcnt(0)
    ds_read_b64_tr_b16 a[0:1], v3 offset:4096
    ds_read_b64_tr_b16 a[2:3], v3 offset:5120
    ds_read_b64_tr_b16 a[4:5], v15 offset:4096
    ds_read_b64_tr_b16 a[6:7], v15 offset:5120
    v_exp_f32 v125, v125
    v_exp_f32 v126, v126
    v_exp_f32 v127, v127
    v_cvt_pk_bf16_f32 v148, v120, v121
    v_cvt_pk_bf16_f32 v149, v122, v123
    v_cvt_pk_bf16_f32 v150, v124, v125
    v_cvt_pk_bf16_f32 v151, v126, v127
    v_mfma_f32_32x32x16_bf16 v[112:127], v[192:195], v[32:35], 0
    s_add_u32 s58, s93, 0
    v_exp_f32 v128, v128
    v_exp_f32 v129, v129
    v_exp_f32 v130, v130
    v_exp_f32 v131, v131
    v_exp_f32 v132, v132
    v_mfma_f32_32x32x16_bf16 v[48:63], v[204:207], v[148:151], v[48:63]
    buffer_load_dwordx4 v4, s[24:27], s58 offen offset:0 lds
    v_exp_f32 v133, v133
    v_exp_f32 v134, v134
    v_exp_f32_e64 v135, v135
    v_cvt_pk_bf16_f32 v144, v128, v129
    v_cvt_pk_bf16_f32 v145, v130, v131
    v_cvt_pk_bf16_f32 v146, v132, v133
    v_cvt_pk_bf16_f32 v147, v134, v135
    v_mfma_f32_32x32x16_bf16 v[112:127], v[196:199], v[36:39], v[112:127]
    buffer_load_dwordx4 v152, s[24:27], s58 offen offset:1024 lds
    v_exp_f32 v136, v136
    v_exp_f32 v137, v137
    v_exp_f32 v138, v138
    v_exp_f32 v139, v139
    v_exp_f32_e64 v140, v140
    v_mfma_f32_32x32x16_bf16 v[64:79], v[200:203], v[144:147], v[64:79]
    s_waitcnt vmcnt(22) lgkmcnt(0)
    ds_read_b64_tr_b16 a[8:9], v3 offset:6144
    ds_read_b64_tr_b16 a[10:11], v3 offset:7168
    ds_read_b64_tr_b16 a[12:13], v15 offset:6144
    ds_read_b64_tr_b16 a[14:15], v15 offset:7168
    v_exp_f32 v141, v141
    v_exp_f32 v142, v142
    v_exp_f32 v143, v143
    v_cvt_pk_bf16_f32 v148, v136, v137
    v_cvt_pk_bf16_f32 v149, v138, v139
    v_cvt_pk_bf16_f32 v150, v140, v141
    v_cvt_pk_bf16_f32 v151, v142, v143
    v_mfma_f32_32x32x16_bf16 v[128:143], v[192:195], v[40:43], 0
    buffer_load_dwordx4 v153, s[24:27], s58 offen offset:2048 lds
    v_exp_f32 v112, v112
    v_exp_f32 v113, v113
    v_exp_f32 v114, v114
    v_exp_f32 v115, v115
    v_exp_f32_e64 v116, v116
    v_mfma_f32_32x32x16_bf16 v[64:79], v[204:207], v[148:151], v[64:79]
    buffer_load_dwordx4 v154, s[24:27], s58 offen offset:3072 lds
    v_exp_f32 v117, v117
    v_exp_f32 v118, v118
    v_exp_f32_e64 v119, v119
    v_cvt_pk_bf16_f32 v144, v112, v113
    v_cvt_pk_bf16_f32 v145, v114, v115
    v_cvt_pk_bf16_f32 v146, v116, v117
    v_cvt_pk_bf16_f32 v147, v118, v119
    v_mfma_f32_32x32x16_bf16 v[128:143], v[196:199], v[44:47], v[128:143]
    s_add_u32 s69, s69, 16384
    s_bitset0_b32 s69, 18
    buffer_load_dwordx4 v[192:195], v2, s[28:31], s69 offen offset:0 sc1
    buffer_load_dwordx4 v[196:199], v2, s[28:31], s69 offen offset:1024 sc1
    v_exp_f32 v120, v120
    v_exp_f32 v121, v121
    v_exp_f32 v122, v122
    v_exp_f32 v123, v123
    v_exp_f32 v124, v124
    v_mfma_f32_32x32x16_bf16 v[80:95], v[200:203], v[144:147], v[80:95]
    s_waitcnt vmcnt(24) lgkmcnt(0)
    ds_read_b64_tr_b16 a[16:17], v3 offset:8192
    ds_read_b64_tr_b16 a[18:19], v3 offset:9216
    ds_read_b64_tr_b16 a[20:21], v15 offset:8192
    ds_read_b64_tr_b16 a[22:23], v15 offset:9216
    v_exp_f32 v125, v125
    v_exp_f32 v126, v126
    v_exp_f32 v127, v127
    v_cvt_pk_bf16_f32 v148, v120, v121
    v_cvt_pk_bf16_f32 v149, v122, v123
    v_cvt_pk_bf16_f32 v150, v124, v125
    v_cvt_pk_bf16_f32 v151, v126, v127
    s_waitcnt vmcnt(22)
    v_mfma_f32_32x32x16_bf16 v[112:127], v[160:163], v[16:19], 0
    s_add_u32 m0, s70, 4096
    v_exp_f32 v128, v128
    v_exp_f32 v129, v129
    v_exp_f32 v130, v130
    v_exp_f32 v131, v131
    v_exp_f32 v132, v132
    v_mfma_f32_32x32x16_bf16 v[80:95], v[204:207], v[148:151], v[80:95]
    s_add_u32 s58, s93, 28672
    v_exp_f32 v133, v133
    v_exp_f32 v134, v134
    v_exp_f32_e64 v135, v135
    v_cvt_pk_bf16_f32 v144, v128, v129
    v_cvt_pk_bf16_f32 v145, v130, v131
    v_cvt_pk_bf16_f32 v146, v132, v133
    v_cvt_pk_bf16_f32 v147, v134, v135
    v_mfma_f32_32x32x16_bf16 v[112:127], v[164:167], v[20:23], v[112:127]
    buffer_load_dwordx4 v4, s[24:27], s58 offen offset:0 lds
    v_exp_f32 v136, v136
    v_exp_f32 v137, v137
    v_exp_f32 v138, v138
    v_exp_f32 v139, v139
    v_exp_f32_e64 v140, v140
    v_mfma_f32_32x32x16_bf16 v[96:111], v[200:203], v[144:147], v[96:111]
    s_waitcnt vmcnt(21) lgkmcnt(0)
    ds_read_b64_tr_b16 a[24:25], v3 offset:10240
    ds_read_b64_tr_b16 a[26:27], v3 offset:11264
    ds_read_b64_tr_b16 a[28:29], v15 offset:10240
    ds_read_b64_tr_b16 a[30:31], v15 offset:11264
    v_exp_f32 v141, v141
    v_exp_f32 v142, v142
    v_exp_f32 v143, v143
    v_cvt_pk_bf16_f32 v148, v136, v137
    v_cvt_pk_bf16_f32 v149, v138, v139
    v_cvt_pk_bf16_f32 v150, v140, v141
    v_cvt_pk_bf16_f32 v151, v142, v143
    v_mfma_f32_32x32x16_bf16 v[128:143], v[160:163], v[24:27], 0
    buffer_load_dwordx4 v152, s[24:27], s58 offen offset:1024 lds
    v_exp_f32 v112, v112
    v_exp_f32 v113, v113
    v_exp_f32 v114, v114
    v_exp_f32 v115, v115
    v_exp_f32_e64 v116, v116
    v_mfma_f32_32x32x16_bf16 v[96:111], v[204:207], v[148:151], v[96:111]
    buffer_load_dwordx4 v[200:203], v2, s[28:31], s69 offen offset:2048 sc1
    buffer_load_dwordx4 v[204:207], v2, s[28:31], s69 offen offset:3072 sc1
    v_exp_f32 v117, v117
    v_exp_f32 v118, v118
    v_exp_f32_e64 v119, v119
    v_cvt_pk_bf16_f32 v144, v112, v113
    v_cvt_pk_bf16_f32 v145, v114, v115
    v_cvt_pk_bf16_f32 v146, v116, v117
    v_cvt_pk_bf16_f32 v147, v118, v119
    v_mfma_f32_32x32x16_bf16 v[128:143], v[164:167], v[28:31], v[128:143]
    buffer_load_dwordx4 v153, s[24:27], s58 offen offset:2048 lds
    v_exp_f32 v120, v120
    v_exp_f32 v121, v121
    v_exp_f32 v122, v122
    v_exp_f32 v123, v123
    v_exp_f32 v124, v124
    s_waitcnt vmcnt(23)
    v_mfma_f32_32x32x16_bf16 v[48:63], v[168:171], v[144:147], v[48:63]
    buffer_load_dwordx4 v154, s[24:27], s58 offen offset:3072 lds
    v_exp_f32 v125, v125
    v_exp_f32 v126, v126
    v_exp_f32_e64 v127, v127
    v_cvt_pk_bf16_f32 v148, v120, v121
    v_cvt_pk_bf16_f32 v149, v122, v123
    v_cvt_pk_bf16_f32 v150, v124, v125
    v_cvt_pk_bf16_f32 v151, v126, v127
    v_mfma_f32_32x32x16_bf16 v[112:127], v[160:163], v[32:35], 0
    s_add_u32 m0, s70, 8192
    v_exp_f32 v128, v128
    v_exp_f32 v129, v129
    v_exp_f32 v130, v130
    v_exp_f32 v131, v131
    v_exp_f32_e64 v132, v132
    v_mfma_f32_32x32x16_bf16 v[48:63], v[172:175], v[148:151], v[48:63]
    s_add_u32 s58, s94, 0
    v_exp_f32 v133, v133
    v_exp_f32 v134, v134
    v_exp_f32 v135, v135
    v_cvt_pk_bf16_f32 v144, v128, v129
    v_cvt_pk_bf16_f32 v145, v130, v131
    v_cvt_pk_bf16_f32 v146, v132, v133
    v_cvt_pk_bf16_f32 v147, v134, v135
    v_mfma_f32_32x32x16_bf16 v[112:127], v[164:167], v[36:39], v[112:127]
    buffer_load_dwordx4 v4, s[24:27], s58 offen offset:0 lds
    v_exp_f32 v136, v136
    v_exp_f32 v137, v137
    v_exp_f32 v138, v138
    v_exp_f32 v139, v139
    v_exp_f32_e64 v140, v140
    v_mfma_f32_32x32x16_bf16 v[64:79], v[168:171], v[144:147], v[64:79]
    s_waitcnt vmcnt(23) lgkmcnt(0)
    ds_read_b64_tr_b16 a[32:33], v3 offset:12288
    ds_read_b64_tr_b16 a[34:35], v3 offset:13312
    ds_read_b64_tr_b16 a[36:37], v15 offset:12288
    ds_read_b64_tr_b16 a[38:39], v15 offset:13312
    v_exp_f32 v141, v141
    v_exp_f32 v142, v142
    v_exp_f32 v143, v143
    v_cvt_pk_bf16_f32 v148, v136, v137
    v_cvt_pk_bf16_f32 v149, v138, v139
    v_cvt_pk_bf16_f32 v150, v140, v141
    v_cvt_pk_bf16_f32 v151, v142, v143
    v_mfma_f32_32x32x16_bf16 v[128:143], v[160:163], v[40:43], 0
    buffer_load_dwordx4 v152, s[24:27], s58 offen offset:1024 lds
    v_exp_f32 v112, v112
    v_exp_f32 v113, v113
    v_exp_f32 v114, v114
    v_exp_f32 v115, v115
    v_exp_f32_e64 v116, v116
    v_mfma_f32_32x32x16_bf16 v[64:79], v[172:175], v[148:151], v[64:79]
    buffer_load_dwordx4 v153, s[24:27], s58 offen offset:2048 lds
    v_exp_f32 v117, v117
    v_exp_f32 v118, v118
    v_exp_f32_e64 v119, v119
    v_cvt_pk_bf16_f32 v144, v112, v113
    v_cvt_pk_bf16_f32 v145, v114, v115
    v_cvt_pk_bf16_f32 v146, v116, v117
    v_cvt_pk_bf16_f32 v147, v118, v119
    v_mfma_f32_32x32x16_bf16 v[128:143], v[164:167], v[44:47], v[128:143]
    s_add_u32 s69, s69, 16384
    s_bitset0_b32 s69, 18
    buffer_load_dwordx4 v[160:163], v2, s[28:31], s69 offen offset:0 sc1
    buffer_load_dwordx4 v[164:167], v2, s[28:31], s69 offen offset:1024 sc1
    v_exp_f32 v120, v120
    v_exp_f32 v121, v121
    v_exp_f32 v122, v122
    v_exp_f32 v123, v123
    v_exp_f32 v124, v124
    v_mfma_f32_32x32x16_bf16 v[80:95], v[168:171], v[144:147], v[80:95]
    s_waitcnt vmcnt(25) lgkmcnt(0)
    ds_read_b64_tr_b16 a[40:41], v3 offset:14336
    ds_read_b64_tr_b16 a[42:43], v3 offset:15360
    ds_read_b64_tr_b16 a[44:45], v15 offset:14336
    ds_read_b64_tr_b16 a[46:47], v15 offset:15360
    v_exp_f32 v125, v125
    v_exp_f32 v126, v126
    v_exp_f32 v127, v127
    v_cvt_pk_bf16_f32 v148, v120, v121
    v_cvt_pk_bf16_f32 v149, v122, v123
    v_cvt_pk_bf16_f32 v150, v124, v125
    v_cvt_pk_bf16_f32 v151, v126, v127
    s_waitcnt vmcnt(23)
    v_mfma_f32_32x32x16_bf16 v[112:127], v[176:179], v[16:19], 0
    buffer_load_dwordx4 v154, s[24:27], s58 offen offset:3072 lds
    v_exp_f32 v128, v128
    v_exp_f32 v129, v129
    v_exp_f32 v130, v130
    v_exp_f32 v131, v131
    v_exp_f32 v132, v132
    v_mfma_f32_32x32x16_bf16 v[80:95], v[172:175], v[148:151], v[80:95]
    s_add_u32 m0, s67, 0
    v_exp_f32 v133, v133
    v_exp_f32 v134, v134
    v_exp_f32 v135, v135
    v_cvt_pk_bf16_f32 v144, v128, v129
    v_cvt_pk_bf16_f32 v145, v130, v131
    v_cvt_pk_bf16_f32 v146, v132, v133
    v_cvt_pk_bf16_f32 v147, v134, v135
    v_mfma_f32_32x32x16_bf16 v[112:127], v[180:183], v[20:23], v[112:127]
    s_add_u32 s58, s94, 28672
    v_exp_f32 v136, v136
    v_exp_f32 v137, v137
    v_exp_f32 v138, v138
    v_exp_f32 v139, v139
    v_exp_f32_e64 v140, v140
    v_mfma_f32_32x32x16_bf16 v[96:111], v[168:171], v[144:147], v[96:111]
    s_waitcnt vmcnt(22) lgkmcnt(0)
    ds_read_b64_tr_b16 a[48:49], v3 offset:16384
    ds_read_b64_tr_b16 a[50:51], v3 offset:17408
    ds_read_b64_tr_b16 a[52:53], v15 offset:16384
    ds_read_b64_tr_b16 a[54:55], v15 offset:17408
    v_exp_f32 v141, v141
    v_exp_f32 v142, v142
    v_exp_f32 v143, v143
    v_cvt_pk_bf16_f32 v148, v136, v137
    v_cvt_pk_bf16_f32 v149, v138, v139
    v_cvt_pk_bf16_f32 v150, v140, v141
    v_cvt_pk_bf16_f32 v151, v142, v143
    v_mfma_f32_32x32x16_bf16 v[128:143], v[176:179], v[24:27], 0
    buffer_load_dwordx4 v4, s[24:27], s58 offen offset:0 lds
    v_exp_f32 v112, v112
    v_exp_f32 v113, v113
    v_exp_f32 v114, v114
    v_exp_f32 v115, v115
    v_exp_f32_e64 v116, v116
    v_mfma_f32_32x32x16_bf16 v[96:111], v[172:175], v[148:151], v[96:111]
    buffer_load_dwordx4 v[168:171], v2, s[28:31], s69 offen offset:2048 sc1
    buffer_load_dwordx4 v[172:175], v2, s[28:31], s69 offen offset:3072 sc1
    v_exp_f32 v117, v117
    v_exp_f32 v118, v118
    v_exp_f32_e64 v119, v119
    v_cvt_pk_bf16_f32 v144, v112, v113
    v_cvt_pk_bf16_f32 v145, v114, v115
    v_cvt_pk_bf16_f32 v146, v116, v117
    v_cvt_pk_bf16_f32 v147, v118, v119
    v_mfma_f32_32x32x16_bf16 v[128:143], v[180:183], v[28:31], v[128:143]
    buffer_load_dwordx4 v152, s[24:27], s58 offen offset:1024 lds
    v_exp_f32 v120, v120
    v_exp_f32 v121, v121
    v_exp_f32 v122, v122
    v_exp_f32 v123, v123
    v_exp_f32 v124, v124
    s_waitcnt vmcnt(22)
    v_mfma_f32_32x32x16_bf16 v[48:63], v[184:187], v[144:147], v[48:63]
    s_waitcnt lgkmcnt(0)
    ds_read_b64_tr_b16 a[56:57], v3 offset:18432
    ds_read_b64_tr_b16 a[58:59], v3 offset:19456
    ds_read_b64_tr_b16 a[60:61], v15 offset:18432
    ds_read_b64_tr_b16 a[62:63], v15 offset:19456
    v_exp_f32 v125, v125
    v_exp_f32 v126, v126
    v_exp_f32 v127, v127
    v_cvt_pk_bf16_f32 v148, v120, v121
    v_cvt_pk_bf16_f32 v149, v122, v123
    v_cvt_pk_bf16_f32 v150, v124, v125
    v_cvt_pk_bf16_f32 v151, v126, v127
    v_mfma_f32_32x32x16_bf16 v[112:127], v[176:179], v[32:35], 0
    buffer_load_dwordx4 v153, s[24:27], s58 offen offset:2048 lds
    v_exp_f32 v128, v128
    v_exp_f32 v129, v129
    v_exp_f32 v130, v130
    v_exp_f32 v131, v131
    v_exp_f32_e64 v132, v132
    v_mfma_f32_32x32x16_bf16 v[48:63], v[188:191], v[148:151], v[48:63]
    buffer_load_dwordx4 v154, s[24:27], s58 offen offset:3072 lds
    v_exp_f32 v133, v133
    v_exp_f32 v134, v134
    v_exp_f32_e64 v135, v135
    v_cvt_pk_bf16_f32 v144, v128, v129
    v_cvt_pk_bf16_f32 v145, v130, v131
    v_cvt_pk_bf16_f32 v146, v132, v133
    v_cvt_pk_bf16_f32 v147, v134, v135
    v_mfma_f32_32x32x16_bf16 v[112:127], v[180:183], v[36:39], v[112:127]
    s_add_u32 m0, s67, 4096
    v_exp_f32 v136, v136
    v_exp_f32 v137, v137
    v_exp_f32 v138, v138
    v_exp_f32 v139, v139
    v_exp_f32_e64 v140, v140
    v_mfma_f32_32x32x16_bf16 v[64:79], v[184:187], v[144:147], v[64:79]
    s_waitcnt vmcnt(22) lgkmcnt(0)
    ds_read_b64_tr_b16 a[64:65], v7 offset:0
    ds_read_b64_tr_b16 a[66:67], v7 offset:1024
    ds_read_b64_tr_b16 a[68:69], v5 offset:0
    ds_read_b64_tr_b16 a[70:71], v5 offset:1024
    v_exp_f32 v141, v141
    v_exp_f32 v142, v142
    v_exp_f32 v143, v143
    v_cvt_pk_bf16_f32 v148, v136, v137
    v_cvt_pk_bf16_f32 v149, v138, v139
    v_cvt_pk_bf16_f32 v150, v140, v141
    v_cvt_pk_bf16_f32 v151, v142, v143
    v_mfma_f32_32x32x16_bf16 v[128:143], v[176:179], v[40:43], 0
    s_add_u32 s58, s95, 0
    v_exp_f32 v112, v112
    v_exp_f32 v113, v113
    v_exp_f32 v114, v114
    v_exp_f32 v115, v115
    v_exp_f32 v116, v116
    v_mfma_f32_32x32x16_bf16 v[64:79], v[188:191], v[148:151], v[64:79]
    buffer_load_dwordx4 v4, s[24:27], s58 offen offset:0 lds
    v_exp_f32 v117, v117
    v_exp_f32 v118, v118
    v_exp_f32_e64 v119, v119
    v_cvt_pk_bf16_f32 v144, v112, v113
    v_cvt_pk_bf16_f32 v145, v114, v115
    v_cvt_pk_bf16_f32 v146, v116, v117
    v_cvt_pk_bf16_f32 v147, v118, v119
    v_mfma_f32_32x32x16_bf16 v[128:143], v[180:183], v[44:47], v[128:143]
    s_add_u32 s69, s69, 16384
    s_bitset0_b32 s69, 18
    buffer_load_dwordx4 v[176:179], v2, s[28:31], s69 offen offset:0 sc1
    buffer_load_dwordx4 v[180:183], v2, s[28:31], s69 offen offset:1024 sc1
    v_exp_f32 v120, v120
    v_exp_f32 v121, v121
    v_exp_f32 v122, v122
    v_exp_f32 v123, v123
    v_exp_f32 v124, v124
    v_mfma_f32_32x32x16_bf16 v[80:95], v[184:187], v[144:147], v[80:95]
    s_waitcnt vmcnt(23) lgkmcnt(0)
    ds_read_b64_tr_b16 a[72:73], v7 offset:2048
    ds_read_b64_tr_b16 a[74:75], v7 offset:3072
    ds_read_b64_tr_b16 a[76:77], v5 offset:2048
    ds_read_b64_tr_b16 a[78:79], v5 offset:3072
    v_exp_f32 v125, v125
    v_exp_f32 v126, v126
    v_exp_f32 v127, v127
    v_cvt_pk_bf16_f32 v148, v120, v121
    v_cvt_pk_bf16_f32 v149, v122, v123
    v_cvt_pk_bf16_f32 v150, v124, v125
    v_cvt_pk_bf16_f32 v151, v126, v127
    s_waitcnt vmcnt(21)
    v_mfma_f32_32x32x16_bf16 v[112:127], v[192:195], v[16:19], 0
    buffer_load_dwordx4 v152, s[24:27], s58 offen offset:1024 lds
    v_exp_f32 v128, v128
    v_exp_f32 v129, v129
    v_exp_f32 v130, v130
    v_exp_f32 v131, v131
    v_exp_f32 v132, v132
    v_mfma_f32_32x32x16_bf16 v[80:95], v[188:191], v[148:151], v[80:95]
    buffer_load_dwordx4 v153, s[24:27], s58 offen offset:2048 lds
    v_exp_f32 v133, v133
    v_exp_f32 v134, v134
    v_exp_f32_e64 v135, v135
    v_cvt_pk_bf16_f32 v144, v128, v129
    v_cvt_pk_bf16_f32 v145, v130, v131
    v_cvt_pk_bf16_f32 v146, v132, v133
    v_cvt_pk_bf16_f32 v147, v134, v135
    v_mfma_f32_32x32x16_bf16 v[112:127], v[196:199], v[20:23], v[112:127]
    buffer_load_dwordx4 v154, s[24:27], s58 offen offset:3072 lds
    v_exp_f32 v136, v136
    v_exp_f32 v137, v137
    v_exp_f32 v138, v138
    v_exp_f32 v139, v139
    v_exp_f32_e64 v140, v140
    v_mfma_f32_32x32x16_bf16 v[96:111], v[184:187], v[144:147], v[96:111]
    s_add_u32 m0, s67, 8192
    v_exp_f32 v141, v141
    v_exp_f32 v142, v142
    v_exp_f32_e64 v143, v143
    v_cvt_pk_bf16_f32 v148, v136, v137
    v_cvt_pk_bf16_f32 v149, v138, v139
    v_cvt_pk_bf16_f32 v150, v140, v141
    v_cvt_pk_bf16_f32 v151, v142, v143
    v_mfma_f32_32x32x16_bf16 v[128:143], v[192:195], v[24:27], 0
    s_add_u32 s58, s95, 28672
    v_exp_f32 v112, v112
    v_exp_f32 v113, v113
    v_exp_f32 v114, v114
    v_exp_f32 v115, v115
    v_exp_f32_e64 v116, v116
    v_mfma_f32_32x32x16_bf16 v[96:111], v[188:191], v[148:151], v[96:111]
    buffer_load_dwordx4 v[184:187], v2, s[28:31], s69 offen offset:2048 sc1
    buffer_load_dwordx4 v[188:191], v2, s[28:31], s69 offen offset:3072 sc1
    v_exp_f32 v117, v117
    v_exp_f32 v118, v118
    v_exp_f32_e64 v119, v119
    v_cvt_pk_bf16_f32 v144, v112, v113
    v_cvt_pk_bf16_f32 v145, v114, v115
    v_cvt_pk_bf16_f32 v146, v116, v117
    v_cvt_pk_bf16_f32 v147, v118, v119
    v_mfma_f32_32x32x16_bf16 v[128:143], v[196:199], v[28:31], v[128:143]
    buffer_load_dwordx4 v4, s[24:27], s58 offen offset:0 lds
    v_exp_f32 v120, v120
    v_exp_f32 v121, v121
    v_exp_f32 v122, v122
    v_exp_f32 v123, v123
    v_exp_f32 v124, v124
    s_waitcnt vmcnt(23)
    v_mfma_f32_32x32x16_bf16 v[48:63], v[200:203], v[144:147], v[48:63]
    s_waitcnt lgkmcnt(0)
    ds_read_b64_tr_b16 a[80:81], v7 offset:4096
    ds_read_b64_tr_b16 a[82:83], v7 offset:5120
    ds_read_b64_tr_b16 a[84:85], v5 offset:4096
    ds_read_b64_tr_b16 a[86:87], v5 offset:5120
    v_exp_f32 v125, v125
    v_exp_f32 v126, v126
    v_exp_f32 v127, v127
    v_cvt_pk_bf16_f32 v148, v120, v121
    v_cvt_pk_bf16_f32 v149, v122, v123
    v_cvt_pk_bf16_f32 v150, v124, v125
    v_cvt_pk_bf16_f32 v151, v126, v127
    v_mfma_f32_32x32x16_bf16 v[112:127], v[192:195], v[32:35], 0
    buffer_load_dwordx4 v152, s[24:27], s58 offen offset:1024 lds
    v_exp_f32 v128, v128
    v_exp_f32 v129, v129
    v_exp_f32 v130, v130
    v_exp_f32 v131, v131
    v_exp_f32_e64 v132, v132
    v_mfma_f32_32x32x16_bf16 v[48:63], v[204:207], v[148:151], v[48:63]
    buffer_load_dwordx4 v153, s[24:27], s58 offen offset:2048 lds
    v_exp_f32 v133, v133
    v_exp_f32 v134, v134
    v_exp_f32_e64 v135, v135
    v_cvt_pk_bf16_f32 v144, v128, v129
    v_cvt_pk_bf16_f32 v145, v130, v131
    v_cvt_pk_bf16_f32 v146, v132, v133
    v_cvt_pk_bf16_f32 v147, v134, v135
    v_mfma_f32_32x32x16_bf16 v[112:127], v[196:199], v[36:39], v[112:127]
    buffer_load_dwordx4 v154, s[24:27], s58 offen offset:3072 lds
    v_exp_f32 v136, v136
    v_exp_f32 v137, v137
    v_exp_f32 v138, v138
    v_exp_f32 v139, v139
    v_exp_f32_e64 v140, v140
    v_mfma_f32_32x32x16_bf16 v[64:79], v[200:203], v[144:147], v[64:79]
    s_waitcnt vmcnt(24) lgkmcnt(0)
    ds_read_b64_tr_b16 a[88:89], v7 offset:6144
    ds_read_b64_tr_b16 a[90:91], v7 offset:7168
    ds_read_b64_tr_b16 a[92:93], v5 offset:6144
    ds_read_b64_tr_b16 a[94:95], v5 offset:7168
    v_exp_f32 v141, v141
    v_exp_f32 v142, v142
    v_exp_f32 v143, v143
    v_cvt_pk_bf16_f32 v148, v136, v137
    v_cvt_pk_bf16_f32 v149, v138, v139
    v_cvt_pk_bf16_f32 v150, v140, v141
    v_cvt_pk_bf16_f32 v151, v142, v143
    v_mfma_f32_32x32x16_bf16 v[128:143], v[192:195], v[40:43], 0
    s_add_u32 m0, s67, 12288
    v_exp_f32 v112, v112
    v_exp_f32 v113, v113
    v_exp_f32 v114, v114
    v_exp_f32 v115, v115
    v_exp_f32_e64 v116, v116
    v_mfma_f32_32x32x16_bf16 v[64:79], v[204:207], v[148:151], v[64:79]
    s_add_u32 s58, s96, 0
    v_exp_f32 v117, v117
    v_exp_f32 v118, v118
    v_exp_f32 v119, v119
    v_cvt_pk_bf16_f32 v144, v112, v113
    v_cvt_pk_bf16_f32 v145, v114, v115
    v_cvt_pk_bf16_f32 v146, v116, v117
    v_cvt_pk_bf16_f32 v147, v118, v119
    v_mfma_f32_32x32x16_bf16 v[128:143], v[196:199], v[44:47], v[128:143]
    s_add_u32 s69, s69, 16384
    s_bitset0_b32 s69, 18
    buffer_load_dwordx4 v[192:195], v2, s[28:31], s69 offen offset:0 sc1
    buffer_load_dwordx4 v[196:199], v2, s[28:31], s69 offen offset:1024 sc1
    v_exp_f32 v120, v120
    v_exp_f32 v121, v121
    v_exp_f32 v122, v122
    v_exp_f32 v123, v123
    v_exp_f32 v124, v124
    v_mfma_f32_32x32x16_bf16 v[80:95], v[200:203], v[144:147], v[80:95]
    s_waitcnt vmcnt(24) lgkmcnt(0)
    ds_read_b64_tr_b16 a[96:97], v7 offset:8192
    ds_read_b64_tr_b16 a[98:99], v7 offset:9216
    ds_read_b64_tr_b16 a[100:101], v5 offset:8192
    ds_read_b64_tr_b16 a[102:103], v5 offset:9216
    v_exp_f32 v125, v125
    v_exp_f32 v126, v126
    v_exp_f32 v127, v127
    v_cvt_pk_bf16_f32 v148, v120, v121
    v_cvt_pk_bf16_f32 v149, v122, v123
    v_cvt_pk_bf16_f32 v150, v124, v125
    v_cvt_pk_bf16_f32 v151, v126, v127
    s_waitcnt vmcnt(21)
    v_mfma_f32_32x32x16_bf16 v[112:127], v[160:163], v[16:19], 0
    buffer_load_dwordx4 v4, s[24:27], s58 offen offset:0 lds
    v_exp_f32 v128, v128
    v_exp_f32 v129, v129
    v_exp_f32 v130, v130
    v_exp_f32 v131, v131
    v_exp_f32 v132, v132
    v_mfma_f32_32x32x16_bf16 v[80:95], v[204:207], v[148:151], v[80:95]
    buffer_load_dwordx4 v152, s[24:27], s58 offen offset:1024 lds
    v_exp_f32 v133, v133
    v_exp_f32 v134, v134
    v_exp_f32_e64 v135, v135
    v_cvt_pk_bf16_f32 v144, v128, v129
    v_cvt_pk_bf16_f32 v145, v130, v131
    v_cvt_pk_bf16_f32 v146, v132, v133
    v_cvt_pk_bf16_f32 v147, v134, v135
    v_mfma_f32_32x32x16_bf16 v[112:127], v[164:167], v[20:23], v[112:127]
    buffer_load_dwordx4 v153, s[24:27], s58 offen offset:2048 lds
    v_exp_f32 v136, v136
    v_exp_f32 v137, v137
    v_exp_f32 v138, v138
    v_exp_f32 v139, v139
    v_exp_f32_e64 v140, v140
    v_mfma_f32_32x32x16_bf16 v[96:111], v[200:203], v[144:147], v[96:111]
    s_waitcnt vmcnt(23) lgkmcnt(0)
    ds_read_b64_tr_b16 a[104:105], v7 offset:10240
    ds_read_b64_tr_b16 a[106:107], v7 offset:11264
    ds_read_b64_tr_b16 a[108:109], v5 offset:10240
    ds_read_b64_tr_b16 a[110:111], v5 offset:11264
    v_exp_f32 v141, v141
    v_exp_f32 v142, v142
    v_exp_f32 v143, v143
    v_cvt_pk_bf16_f32 v148, v136, v137
    v_cvt_pk_bf16_f32 v149, v138, v139
    v_cvt_pk_bf16_f32 v150, v140, v141
    v_cvt_pk_bf16_f32 v151, v142, v143
    v_mfma_f32_32x32x16_bf16 v[128:143], v[160:163], v[24:27], 0
    buffer_load_dwordx4 v154, s[24:27], s58 offen offset:3072 lds
    v_exp_f32 v112, v112
    v_exp_f32 v113, v113
    v_exp_f32 v114, v114
    v_exp_f32 v115, v115
    v_exp_f32_e64 v116, v116
    v_mfma_f32_32x32x16_bf16 v[96:111], v[204:207], v[148:151], v[96:111]
    buffer_load_dwordx4 v[200:203], v2, s[28:31], s69 offen offset:2048 sc1
    buffer_load_dwordx4 v[204:207], v2, s[28:31], s69 offen offset:3072 sc1
    v_exp_f32 v117, v117
    v_exp_f32 v118, v118
    v_exp_f32_e64 v119, v119
    v_cvt_pk_bf16_f32 v144, v112, v113
    v_cvt_pk_bf16_f32 v145, v114, v115
    v_cvt_pk_bf16_f32 v146, v116, v117
    v_cvt_pk_bf16_f32 v147, v118, v119
    v_mfma_f32_32x32x16_bf16 v[128:143], v[164:167], v[28:31], v[128:143]
    s_add_u32 m0, s67, 16384
    v_exp_f32 v120, v120
    v_exp_f32 v121, v121
    v_exp_f32 v122, v122
    v_exp_f32 v123, v123
    v_exp_f32 v124, v124
    s_waitcnt vmcnt(23)
    v_mfma_f32_32x32x16_bf16 v[48:63], v[168:171], v[144:147], v[48:63]
    s_waitcnt vmcnt(22) lgkmcnt(0)
    ds_read_b64_tr_b16 a[112:113], v3 offset:0
    ds_read_b64_tr_b16 a[114:115], v3 offset:1024
    ds_read_b64_tr_b16 a[116:117], v15 offset:0
    ds_read_b64_tr_b16 a[118:119], v15 offset:1024
    v_exp_f32 v125, v125
    v_exp_f32 v126, v126
    v_exp_f32 v127, v127
    v_cvt_pk_bf16_f32 v148, v120, v121
    v_cvt_pk_bf16_f32 v149, v122, v123
    v_cvt_pk_bf16_f32 v150, v124, v125
    v_cvt_pk_bf16_f32 v151, v126, v127
    v_mfma_f32_32x32x16_bf16 v[112:127], v[160:163], v[32:35], 0
    s_add_u32 s58, s96, 28672
    v_exp_f32 v128, v128
    v_exp_f32 v129, v129
    v_exp_f32 v130, v130
    v_exp_f32 v131, v131
    v_exp_f32_e64 v132, v132
    v_mfma_f32_32x32x16_bf16 v[48:63], v[172:175], v[148:151], v[48:63]
    buffer_load_dwordx4 v4, s[24:27], s58 offen offset:0 lds
    v_exp_f32 v133, v133
    v_exp_f32 v134, v134
    v_exp_f32_e64 v135, v135
    v_cvt_pk_bf16_f32 v144, v128, v129
    v_cvt_pk_bf16_f32 v145, v130, v131
    v_cvt_pk_bf16_f32 v146, v132, v133
    v_cvt_pk_bf16_f32 v147, v134, v135
    v_mfma_f32_32x32x16_bf16 v[112:127], v[164:167], v[36:39], v[112:127]
    buffer_load_dwordx4 v152, s[24:27], s58 offen offset:1024 lds
    v_exp_f32 v136, v136
    v_exp_f32 v137, v137
    v_exp_f32 v138, v138
    v_exp_f32 v139, v139
    v_exp_f32_e64 v140, v140
    v_mfma_f32_32x32x16_bf16 v[64:79], v[168:171], v[144:147], v[64:79]
    s_waitcnt vmcnt(22) lgkmcnt(0)
    ds_read_b64_tr_b16 a[120:121], v3 offset:2048
    ds_read_b64_tr_b16 a[122:123], v3 offset:3072
    ds_read_b64_tr_b16 a[124:125], v15 offset:2048
    ds_read_b64_tr_b16 a[126:127], v15 offset:3072
    v_exp_f32 v141, v141
    v_exp_f32 v142, v142
    v_exp_f32 v143, v143
    v_cvt_pk_bf16_f32 v148, v136, v137
    v_cvt_pk_bf16_f32 v149, v138, v139
    v_cvt_pk_bf16_f32 v150, v140, v141
    v_cvt_pk_bf16_f32 v151, v142, v143
    v_mfma_f32_32x32x16_bf16 v[128:143], v[160:163], v[40:43], 0
    buffer_load_dwordx4 v153, s[24:27], s58 offen offset:2048 lds
    v_exp_f32 v112, v112
    v_exp_f32 v113, v113
    v_exp_f32 v114, v114
    v_exp_f32 v115, v115
    v_exp_f32_e64 v116, v116
    v_mfma_f32_32x32x16_bf16 v[64:79], v[172:175], v[148:151], v[64:79]
    buffer_load_dwordx4 v154, s[24:27], s58 offen offset:3072 lds
    v_exp_f32 v117, v117
    v_exp_f32 v118, v118
    v_exp_f32_e64 v119, v119
    v_cvt_pk_bf16_f32 v144, v112, v113
    v_cvt_pk_bf16_f32 v145, v114, v115
    v_cvt_pk_bf16_f32 v146, v116, v117
    v_cvt_pk_bf16_f32 v147, v118, v119
    v_mfma_f32_32x32x16_bf16 v[128:143], v[164:167], v[44:47], v[128:143]
    s_add_u32 s69, s69, 16384
    s_bitset0_b32 s69, 18
    buffer_load_dwordx4 v[160:163], v2, s[28:31], s69 offen offset:0 sc1
    buffer_load_dwordx4 v[164:167], v2, s[28:31], s69 offen offset:1024 sc1
    v_exp_f32 v120, v120
    v_exp_f32 v121, v121
    v_exp_f32 v122, v122
    v_exp_f32 v123, v123
    v_exp_f32 v124, v124
    v_mfma_f32_32x32x16_bf16 v[80:95], v[168:171], v[144:147], v[80:95]
    s_add_u32 m0, s70, 0
    v_exp_f32 v125, v125
    v_exp_f32 v126, v126
    v_exp_f32 v127, v127
    v_cvt_pk_bf16_f32 v148, v120, v121
    v_cvt_pk_bf16_f32 v149, v122, v123
    v_cvt_pk_bf16_f32 v150, v124, v125
    v_cvt_pk_bf16_f32 v151, v126, v127
    s_waitcnt vmcnt(23)
    v_mfma_f32_32x32x16_bf16 v[112:127], v[176:179], v[16:19], 0
    s_add_u32 s58, s97, 0
    v_exp_f32 v128, v128
    v_exp_f32 v129, v129
    v_exp_f32 v130, v130
    v_exp_f32 v131, v131
    v_exp_f32_e64 v132, v132
    v_mfma_f32_32x32x16_bf16 v[80:95], v[172:175], v[148:151], v[80:95]
    buffer_load_dwordx4 v4, s[24:27], s58 offen offset:0 lds
    v_exp_f32 v133, v133
    v_exp_f32 v134, v134
    v_exp_f32_e64 v135, v135
    v_cvt_pk_bf16_f32 v144, v128, v129
    v_cvt_pk_bf16_f32 v145, v130, v131
    v_cvt_pk_bf16_f32 v146, v132, v133
    v_cvt_pk_bf16_f32 v147, v134, v135
    v_mfma_f32_32x32x16_bf16 v[112:127], v[180:183], v[20:23], v[112:127]
    buffer_load_dwordx4 v152, s[24:27], s58 offen offset:1024 lds
    v_exp_f32 v136, v136
    v_exp_f32 v137, v137
    v_exp_f32 v138, v138
    v_exp_f32 v139, v139
    v_exp_f32_e64 v140, v140
    v_mfma_f32_32x32x16_bf16 v[96:111], v[168:171], v[144:147], v[96:111]
    s_waitcnt vmcnt(24) lgkmcnt(0)
    ds_read_b64_tr_b16 a[128:129], v3 offset:4096
    ds_read_b64_tr_b16 a[130:131], v3 offset:5120
    ds_read_b64_tr_b16 a[132:133], v15 offset:4096
    ds_read_b64_tr_b16 a[134:135], v15 offset:5120
    v_exp_f32 v141, v141
    v_exp_f32 v142, v142
    v_exp_f32 v143, v143
    v_cvt_pk_bf16_f32 v148, v136, v137
    v_cvt_pk_bf16_f32 v149, v138, v139
    v_cvt_pk_bf16_f32 v150, v140, v141
    v_cvt_pk_bf16_f32 v151, v142, v143
    v_mfma_f32_32x32x16_bf16 v[128:143], v[176:179], v[24:27], 0
    buffer_load_dwordx4 v153, s[24:27], s58 offen offset:2048 lds
    v_exp_f32 v112, v112
    v_exp_f32 v113, v113
    v_exp_f32 v114, v114
    v_exp_f32 v115, v115
    v_exp_f32_e64 v116, v116
    v_mfma_f32_32x32x16_bf16 v[96:111], v[172:175], v[148:151], v[96:111]
    buffer_load_dwordx4 v[168:171], v2, s[28:31], s69 offen offset:2048 sc1
    buffer_load_dwordx4 v[172:175], v2, s[28:31], s69 offen offset:3072 sc1
    v_exp_f32 v117, v117
    v_exp_f32 v118, v118
    v_exp_f32_e64 v119, v119
    v_cvt_pk_bf16_f32 v144, v112, v113
    v_cvt_pk_bf16_f32 v145, v114, v115
    v_cvt_pk_bf16_f32 v146, v116, v117
    v_cvt_pk_bf16_f32 v147, v118, v119
    v_mfma_f32_32x32x16_bf16 v[128:143], v[180:183], v[28:31], v[128:143]
    buffer_load_dwordx4 v154, s[24:27], s58 offen offset:3072 lds
    v_exp_f32 v120, v120
    v_exp_f32 v121, v121
    v_exp_f32 v122, v122
    v_exp_f32 v123, v123
    v_exp_f32 v124, v124
    s_waitcnt vmcnt(24)
    v_mfma_f32_32x32x16_bf16 v[48:63], v[184:187], v[144:147], v[48:63]
    s_waitcnt lgkmcnt(0)
    ds_read_b64_tr_b16 a[136:137], v3 offset:6144
    ds_read_b64_tr_b16 a[138:139], v3 offset:7168
    ds_read_b64_tr_b16 a[140:141], v15 offset:6144
    ds_read_b64_tr_b16 a[142:143], v15 offset:7168
    v_exp_f32 v125, v125
    v_exp_f32 v126, v126
    v_exp_f32 v127, v127
    v_cvt_pk_bf16_f32 v148, v120, v121
    v_cvt_pk_bf16_f32 v149, v122, v123
    v_cvt_pk_bf16_f32 v150, v124, v125
    v_cvt_pk_bf16_f32 v151, v126, v127
    v_mfma_f32_32x32x16_bf16 v[112:127], v[176:179], v[32:35], 0
    s_add_u32 m0, s70, 4096
    v_exp_f32 v128, v128
    v_exp_f32 v129, v129
    v_exp_f32 v130, v130
    v_exp_f32 v131, v131
    v_exp_f32_e64 v132, v132
    v_mfma_f32_32x32x16_bf16 v[48:63], v[188:191], v[148:151], v[48:63]
    s_add_u32 s58, s97, 28672
    v_exp_f32 v133, v133
    v_exp_f32 v134, v134
    v_exp_f32_e64 v135, v135
    v_cvt_pk_bf16_f32 v144, v128, v129
    v_cvt_pk_bf16_f32 v145, v130, v131
    v_cvt_pk_bf16_f32 v146, v132, v133
    v_cvt_pk_bf16_f32 v147, v134, v135
    v_mfma_f32_32x32x16_bf16 v[112:127], v[180:183], v[36:39], v[112:127]
    buffer_load_dwordx4 v4, s[24:27], s58 offen offset:0 lds
    v_exp_f32 v136, v136
    v_exp_f32 v137, v137
    v_exp_f32 v138, v138
    v_exp_f32 v139, v139
    v_exp_f32_e64 v140, v140
    v_mfma_f32_32x32x16_bf16 v[64:79], v[184:187], v[144:147], v[64:79]
    s_waitcnt vmcnt(23) lgkmcnt(0)
    ds_read_b64_tr_b16 a[144:145], v3 offset:8192
    ds_read_b64_tr_b16 a[146:147], v3 offset:9216
    ds_read_b64_tr_b16 a[148:149], v15 offset:8192
    ds_read_b64_tr_b16 a[150:151], v15 offset:9216
    v_exp_f32 v141, v141
    v_exp_f32 v142, v142
    v_exp_f32 v143, v143
    v_cvt_pk_bf16_f32 v148, v136, v137
    v_cvt_pk_bf16_f32 v149, v138, v139
    v_cvt_pk_bf16_f32 v150, v140, v141
    v_cvt_pk_bf16_f32 v151, v142, v143
    v_mfma_f32_32x32x16_bf16 v[128:143], v[176:179], v[40:43], 0
    buffer_load_dwordx4 v152, s[24:27], s58 offen offset:1024 lds
    v_exp_f32 v112, v112
    v_exp_f32 v113, v113
    v_exp_f32 v114, v114
    v_exp_f32 v115, v115
    v_exp_f32_e64 v116, v116
    v_mfma_f32_32x32x16_bf16 v[64:79], v[188:191], v[148:151], v[64:79]
    buffer_load_dwordx4 v153, s[24:27], s58 offen offset:2048 lds
    v_exp_f32 v117, v117
    v_exp_f32 v118, v118
    v_exp_f32_e64 v119, v119
    v_cvt_pk_bf16_f32 v144, v112, v113
    v_cvt_pk_bf16_f32 v145, v114, v115
    v_cvt_pk_bf16_f32 v146, v116, v117
    v_cvt_pk_bf16_f32 v147, v118, v119
    v_mfma_f32_32x32x16_bf16 v[128:143], v[180:183], v[44:47], v[128:143]
    s_add_u32 s69, s69, 16384
    s_bitset0_b32 s69, 18
    buffer_load_dwordx4 v[176:179], v2, s[28:31], s69 offen offset:0 sc1
    buffer_load_dwordx4 v[180:183], v2, s[28:31], s69 offen offset:1024 sc1
    v_exp_f32 v120, v120
    v_exp_f32 v121, v121
    v_exp_f32 v122, v122
    v_exp_f32 v123, v123
    v_exp_f32 v124, v124
    v_mfma_f32_32x32x16_bf16 v[80:95], v[184:187], v[144:147], v[80:95]
    s_waitcnt vmcnt(25) lgkmcnt(0)
    ds_read_b64_tr_b16 a[152:153], v3 offset:10240
    ds_read_b64_tr_b16 a[154:155], v3 offset:11264
    ds_read_b64_tr_b16 a[156:157], v15 offset:10240
    ds_read_b64_tr_b16 a[158:159], v15 offset:11264
    v_exp_f32 v125, v125
    v_exp_f32 v126, v126
    v_exp_f32 v127, v127
    v_cvt_pk_bf16_f32 v148, v120, v121
    v_cvt_pk_bf16_f32 v149, v122, v123
    v_cvt_pk_bf16_f32 v150, v124, v125
    v_cvt_pk_bf16_f32 v151, v126, v127
    s_waitcnt vmcnt(23)
    v_mfma_f32_32x32x16_bf16 v[112:127], v[192:195], v[16:19], 0
    buffer_load_dwordx4 v154, s[24:27], s58 offen offset:3072 lds
    v_exp_f32 v128, v128
    v_exp_f32 v129, v129
    v_exp_f32 v130, v130
    v_exp_f32 v131, v131
    v_exp_f32 v132, v132
    v_mfma_f32_32x32x16_bf16 v[80:95], v[188:191], v[148:151], v[80:95]
    v_add_u32 v152, 27648, v6
    v_add_u32 v153, 55296, v6
    v_add_u32 v154, 82944, v6
    v_exp_f32 v133, v133
    v_exp_f32 v134, v134
    v_exp_f32_e64 v135, v135
    v_cvt_pk_bf16_f32 v144, v128, v129
    v_cvt_pk_bf16_f32 v145, v130, v131
    v_cvt_pk_bf16_f32 v146, v132, v133
    v_cvt_pk_bf16_f32 v147, v134, v135
    v_mfma_f32_32x32x16_bf16 v[112:127], v[196:199], v[20:23], v[112:127]
    s_add_u32 m0, s67, 20480
    v_exp_f32 v136, v136
    v_exp_f32 v137, v137
    v_exp_f32 v138, v138
    v_exp_f32 v139, v139
    v_exp_f32_e64 v140, v140
    v_mfma_f32_32x32x16_bf16 v[96:111], v[184:187], v[144:147], v[96:111]
    s_waitcnt vmcnt(22) lgkmcnt(0)
    ds_read_b64_tr_b16 a[160:161], v3 offset:12288
    ds_read_b64_tr_b16 a[162:163], v3 offset:13312
    ds_read_b64_tr_b16 a[164:165], v15 offset:12288
    ds_read_b64_tr_b16 a[166:167], v15 offset:13312
    v_exp_f32 v141, v141
    v_exp_f32 v142, v142
    v_exp_f32 v143, v143
    v_cvt_pk_bf16_f32 v148, v136, v137
    v_cvt_pk_bf16_f32 v149, v138, v139
    v_cvt_pk_bf16_f32 v150, v140, v141
    v_cvt_pk_bf16_f32 v151, v142, v143
    v_mfma_f32_32x32x16_bf16 v[128:143], v[192:195], v[24:27], 0
    s_add_u32 s58, s73, 573440
    v_exp_f32 v112, v112
    v_exp_f32 v113, v113
    v_exp_f32 v114, v114
    v_exp_f32 v115, v115
    v_exp_f32_e64 v116, v116
    v_mfma_f32_32x32x16_bf16 v[96:111], v[188:191], v[148:151], v[96:111]
    buffer_load_dwordx4 v[184:187], v2, s[28:31], s69 offen offset:2048 sc1
    buffer_load_dwordx4 v[188:191], v2, s[28:31], s69 offen offset:3072 sc1
    v_exp_f32 v117, v117
    v_exp_f32 v118, v118
    v_exp_f32_e64 v119, v119
    v_cvt_pk_bf16_f32 v144, v112, v113
    v_cvt_pk_bf16_f32 v145, v114, v115
    v_cvt_pk_bf16_f32 v146, v116, v117
    v_cvt_pk_bf16_f32 v147, v118, v119
    v_mfma_f32_32x32x16_bf16 v[128:143], v[196:199], v[28:31], v[128:143]
    buffer_load_dwordx4 v6, s[20:23], s58 offen offset:0 lds
    v_exp_f32 v120, v120
    v_exp_f32 v121, v121
    v_exp_f32 v122, v122
    v_exp_f32 v123, v123
    v_exp_f32 v124, v124
    s_waitcnt vmcnt(21)
    v_mfma_f32_32x32x16_bf16 v[48:63], v[200:203], v[144:147], v[48:63]
    s_waitcnt lgkmcnt(0)
    ds_read_b64_tr_b16 a[168:169], v3 offset:14336
    ds_read_b64_tr_b16 a[170:171], v3 offset:15360
    ds_read_b64_tr_b16 a[172:173], v15 offset:14336
    ds_read_b64_tr_b16 a[174:175], v15 offset:15360
    v_exp_f32 v125, v125
    v_exp_f32 v126, v126
    v_exp_f32 v127, v127
    v_cvt_pk_bf16_f32 v148, v120, v121
    v_cvt_pk_bf16_f32 v149, v122, v123
    v_cvt_pk_bf16_f32 v150, v124, v125
    v_cvt_pk_bf16_f32 v151, v126, v127
    v_mfma_f32_32x32x16_bf16 v[112:127], v[192:195], v[32:35], 0
    buffer_load_dwordx4 v152, s[20:23], s58 offen offset:1024 lds
    v_exp_f32 v128, v128
    v_exp_f32 v129, v129
    v_exp_f32 v130, v130
    v_exp_f32 v131, v131
    v_exp_f32_e64 v132, v132
    v_mfma_f32_32x32x16_bf16 v[48:63], v[204:207], v[148:151], v[48:63]
    buffer_load_dwordx4 v153, s[20:23], s58 offen offset:2048 lds
    v_exp_f32 v133, v133
    v_exp_f32 v134, v134
    v_exp_f32_e64 v135, v135
    v_cvt_pk_bf16_f32 v144, v128, v129
    v_cvt_pk_bf16_f32 v145, v130, v131
    v_cvt_pk_bf16_f32 v146, v132, v133
    v_cvt_pk_bf16_f32 v147, v134, v135
    v_mfma_f32_32x32x16_bf16 v[112:127], v[196:199], v[36:39], v[112:127]
    buffer_load_dwordx4 v154, s[20:23], s58 offen offset:3072 lds
    v_exp_f32 v136, v136
    v_exp_f32 v137, v137
    v_exp_f32 v138, v138
    v_exp_f32 v139, v139
    v_exp_f32_e64 v140, v140
    v_mfma_f32_32x32x16_bf16 v[64:79], v[200:203], v[144:147], v[64:79]
    s_waitcnt vmcnt(22) lgkmcnt(0)
    ds_read_b64_tr_b16 a[176:177], v3 offset:16384
    ds_read_b64_tr_b16 a[178:179], v3 offset:17408
    ds_read_b64_tr_b16 a[180:181], v15 offset:16384
    ds_read_b64_tr_b16 a[182:183], v15 offset:17408
    v_exp_f32 v141, v141
    v_exp_f32 v142, v142
    v_exp_f32 v143, v143
    v_cvt_pk_bf16_f32 v148, v136, v137
    v_cvt_pk_bf16_f32 v149, v138, v139
    v_cvt_pk_bf16_f32 v150, v140, v141
    v_cvt_pk_bf16_f32 v151, v142, v143
    v_mfma_f32_32x32x16_bf16 v[128:143], v[192:195], v[40:43], 0
    s_add_u32 m0, s67, 24576
    v_exp_f32 v112, v112
    v_exp_f32 v113, v113
    v_exp_f32 v114, v114
    v_exp_f32 v115, v115
    v_exp_f32_e64 v116, v116
    v_mfma_f32_32x32x16_bf16 v[64:79], v[204:207], v[148:151], v[64:79]
    s_add_u32 s58, s73, 688128
    v_exp_f32 v117, v117
    v_exp_f32 v118, v118
    v_exp_f32_e64 v119, v119
    v_cvt_pk_bf16_f32 v144, v112, v113
    v_cvt_pk_bf16_f32 v145, v114, v115
    v_cvt_pk_bf16_f32 v146, v116, v117
    v_cvt_pk_bf16_f32 v147, v118, v119
    v_mfma_f32_32x32x16_bf16 v[128:143], v[196:199], v[44:47], v[128:143]
    s_add_u32 s69, s69, 16384
    s_bitset0_b32 s69, 18
    buffer_load_dwordx4 v[192:195], v2, s[28:31], s69 offen offset:0 sc1
    buffer_load_dwordx4 v[196:199], v2, s[28:31], s69 offen offset:1024 sc1
    v_exp_f32 v120, v120
    v_exp_f32 v121, v121
    v_exp_f32 v122, v122
    v_exp_f32 v123, v123
    v_exp_f32 v124, v124
    v_mfma_f32_32x32x16_bf16 v[80:95], v[200:203], v[144:147], v[80:95]
    s_waitcnt vmcnt(22) lgkmcnt(0)
    ds_read_b64_tr_b16 a[184:185], v3 offset:18432
    ds_read_b64_tr_b16 a[186:187], v3 offset:19456
    ds_read_b64_tr_b16 a[188:189], v15 offset:18432
    ds_read_b64_tr_b16 a[190:191], v15 offset:19456
    v_exp_f32 v125, v125
    v_exp_f32 v126, v126
    v_exp_f32 v127, v127
    v_cvt_pk_bf16_f32 v148, v120, v121
    v_cvt_pk_bf16_f32 v149, v122, v123
    v_cvt_pk_bf16_f32 v150, v124, v125
    v_cvt_pk_bf16_f32 v151, v126, v127
    s_waitcnt vmcnt(20)
    v_mfma_f32_32x32x16_bf16 v[112:127], v[160:163], v[16:19], 0
    buffer_load_dwordx4 v6, s[20:23], s58 offen offset:0 lds
    v_exp_f32 v128, v128
    v_exp_f32 v129, v129
    v_exp_f32 v130, v130
    v_exp_f32 v131, v131
    v_exp_f32 v132, v132
    v_mfma_f32_32x32x16_bf16 v[80:95], v[204:207], v[148:151], v[80:95]
    buffer_load_dwordx4 v152, s[20:23], s58 offen offset:1024 lds
    v_exp_f32 v133, v133
    v_exp_f32 v134, v134
    v_exp_f32_e64 v135, v135
    v_cvt_pk_bf16_f32 v144, v128, v129
    v_cvt_pk_bf16_f32 v145, v130, v131
    v_cvt_pk_bf16_f32 v146, v132, v133
    v_cvt_pk_bf16_f32 v147, v134, v135
    v_mfma_f32_32x32x16_bf16 v[112:127], v[164:167], v[20:23], v[112:127]
    buffer_load_dwordx4 v153, s[20:23], s58 offen offset:2048 lds
    v_exp_f32 v136, v136
    v_exp_f32 v137, v137
    v_exp_f32 v138, v138
    v_exp_f32 v139, v139
    v_exp_f32_e64 v140, v140
    v_mfma_f32_32x32x16_bf16 v[96:111], v[200:203], v[144:147], v[96:111]
    s_waitcnt vmcnt(21) lgkmcnt(0)
    ds_read_b64_tr_b16 a[192:193], v7 offset:0
    ds_read_b64_tr_b16 a[194:195], v7 offset:1024
    ds_read_b64_tr_b16 a[196:197], v5 offset:0
    ds_read_b64_tr_b16 a[198:199], v5 offset:1024
    v_exp_f32 v141, v141
    v_exp_f32 v142, v142
    v_exp_f32 v143, v143
    v_cvt_pk_bf16_f32 v148, v136, v137
    v_cvt_pk_bf16_f32 v149, v138, v139
    v_cvt_pk_bf16_f32 v150, v140, v141
    v_cvt_pk_bf16_f32 v151, v142, v143
    v_mfma_f32_32x32x16_bf16 v[128:143], v[160:163], v[24:27], 0
    buffer_load_dwordx4 v154, s[20:23], s58 offen offset:3072 lds
    v_exp_f32 v112, v112
    v_exp_f32 v113, v113
    v_exp_f32 v114, v114
    v_exp_f32 v115, v115
    v_exp_f32_e64 v116, v116
    v_mfma_f32_32x32x16_bf16 v[96:111], v[204:207], v[148:151], v[96:111]
    buffer_load_dwordx4 v[200:203], v2, s[28:31], s69 offen offset:2048 sc1
    buffer_load_dwordx4 v[204:207], v2, s[28:31], s69 offen offset:3072 sc1
    v_exp_f32 v117, v117
    v_exp_f32 v118, v118
    v_exp_f32_e64 v119, v119
    v_cvt_pk_bf16_f32 v144, v112, v113
    v_cvt_pk_bf16_f32 v145, v114, v115
    v_cvt_pk_bf16_f32 v146, v116, v117
    v_cvt_pk_bf16_f32 v147, v118, v119
    v_mfma_f32_32x32x16_bf16 v[128:143], v[164:167], v[28:31], v[128:143]
    s_add_u32 m0, s67, 0
    v_exp_f32 v120, v120
    v_exp_f32 v121, v121
    v_exp_f32 v122, v122
    v_exp_f32 v123, v123
    v_exp_f32_e64 v124, v124
    s_waitcnt vmcnt(21)
    v_mfma_f32_32x32x16_bf16 v[48:63], v[168:171], v[144:147], v[48:63]
    s_waitcnt vmcnt(20) lgkmcnt(0)
    ds_read_b64_tr_b16 a[200:201], v7 offset:2048
    ds_read_b64_tr_b16 a[202:203], v7 offset:3072
    ds_read_b64_tr_b16 a[204:205], v5 offset:2048
    ds_read_b64_tr_b16 a[206:207], v5 offset:3072
    v_exp_f32 v125, v125
    v_exp_f32 v126, v126
    v_exp_f32 v127, v127
    v_cvt_pk_bf16_f32 v148, v120, v121
    v_cvt_pk_bf16_f32 v149, v122, v123
    v_cvt_pk_bf16_f32 v150, v124, v125
    v_cvt_pk_bf16_f32 v151, v126, v127
    v_mfma_f32_32x32x16_bf16 v[112:127], v[160:163], v[32:35], 0
    s_add_u32 s58, s73, 0
    v_exp_f32 v128, v128
    v_exp_f32 v129, v129
    v_exp_f32 v130, v130
    v_exp_f32 v131, v131
    v_exp_f32 v132, v132
    v_mfma_f32_32x32x16_bf16 v[48:63], v[172:175], v[148:151], v[48:63]
    buffer_load_dwordx4 v6, s[20:23], s58 offen offset:0 lds
    v_exp_f32 v133, v133
    v_exp_f32 v134, v134
    v_exp_f32_e64 v135, v135
    v_cvt_pk_bf16_f32 v144, v128, v129
    v_cvt_pk_bf16_f32 v145, v130, v131
    v_cvt_pk_bf16_f32 v146, v132, v133
    v_cvt_pk_bf16_f32 v147, v134, v135
    v_mfma_f32_32x32x16_bf16 v[112:127], v[164:167], v[36:39], v[112:127]
    buffer_load_dwordx4 v152, s[20:23], s58 offen offset:1024 lds
    v_exp_f32 v136, v136
    v_exp_f32 v137, v137
    v_exp_f32 v138, v138
    v_exp_f32 v139, v139
    v_exp_f32_e64 v140, v140
    v_mfma_f32_32x32x16_bf16 v[64:79], v[168:171], v[144:147], v[64:79]
    buffer_load_dwordx4 v153, s[20:23], s58 offen offset:2048 lds
    v_exp_f32 v141, v141
    v_exp_f32 v142, v142
    v_exp_f32_e64 v143, v143
    v_cvt_pk_bf16_f32 v148, v136, v137
    v_cvt_pk_bf16_f32 v149, v138, v139
    v_cvt_pk_bf16_f32 v150, v140, v141
    v_cvt_pk_bf16_f32 v151, v142, v143
    v_mfma_f32_32x32x16_bf16 v[128:143], v[160:163], v[40:43], 0
    buffer_load_dwordx4 v154, s[20:23], s58 offen offset:3072 lds
    v_exp_f32 v112, v112
    v_exp_f32 v113, v113
    v_exp_f32 v114, v114
    v_exp_f32 v115, v115
    v_exp_f32_e64 v116, v116
    v_mfma_f32_32x32x16_bf16 v[64:79], v[172:175], v[148:151], v[64:79]
    s_add_u32 m0, s67, 4096
    v_exp_f32 v117, v117
    v_exp_f32 v118, v118
    v_exp_f32_e64 v119, v119
    v_cvt_pk_bf16_f32 v144, v112, v113
    v_cvt_pk_bf16_f32 v145, v114, v115
    v_cvt_pk_bf16_f32 v146, v116, v117
    v_cvt_pk_bf16_f32 v147, v118, v119
    v_mfma_f32_32x32x16_bf16 v[128:143], v[164:167], v[44:47], v[128:143]
    s_add_u32 s69, s69, 16384
    s_bitset0_b32 s69, 18
    buffer_load_dwordx4 v[160:163], v2, s[28:31], s69 offen offset:0 sc1
    buffer_load_dwordx4 v[164:167], v2, s[28:31], s69 offen offset:1024 sc1
    v_exp_f32 v120, v120
    v_exp_f32 v121, v121
    v_exp_f32 v122, v122
    v_exp_f32 v123, v123
    v_exp_f32 v124, v124
    v_mfma_f32_32x32x16_bf16 v[80:95], v[168:171], v[144:147], v[80:95]
    s_waitcnt vmcnt(24) lgkmcnt(0)
    ds_read_b64_tr_b16 a[208:209], v7 offset:4096
    ds_read_b64_tr_b16 a[210:211], v7 offset:5120
    ds_read_b64_tr_b16 a[212:213], v5 offset:4096
    ds_read_b64_tr_b16 a[214:215], v5 offset:5120
    v_exp_f32 v125, v125
    v_exp_f32 v126, v126
    v_exp_f32 v127, v127
    v_cvt_pk_bf16_f32 v148, v120, v121
    v_cvt_pk_bf16_f32 v149, v122, v123
    v_cvt_pk_bf16_f32 v150, v124, v125
    v_cvt_pk_bf16_f32 v151, v126, v127
    s_waitcnt vmcnt(21)
    v_mfma_f32_32x32x16_bf16 v[112:127], v[176:179], v[16:19], 0
    s_add_u32 s58, s73, 114688
    v_exp_f32 v128, v128
    v_exp_f32 v129, v129
    v_exp_f32 v130, v130
    v_exp_f32 v131, v131
    v_exp_f32 v132, v132
    v_mfma_f32_32x32x16_bf16 v[80:95], v[172:175], v[148:151], v[80:95]
    buffer_load_dwordx4 v6, s[20:23], s58 offen offset:0 lds
    v_exp_f32 v133, v133
    v_exp_f32 v134, v134
    v_exp_f32_e64 v135, v135
    v_cvt_pk_bf16_f32 v144, v128, v129
    v_cvt_pk_bf16_f32 v145, v130, v131
    v_cvt_pk_bf16_f32 v146, v132, v133
    v_cvt_pk_bf16_f32 v147, v134, v135
    v_mfma_f32_32x32x16_bf16 v[112:127], v[180:183], v[20:23], v[112:127]
    buffer_load_dwordx4 v152, s[20:23], s58 offen offset:1024 lds
    v_exp_f32 v136, v136
    v_exp_f32 v137, v137
    v_exp_f32 v138, v138
    v_exp_f32 v139, v139
    v_exp_f32_e64 v140, v140
    v_mfma_f32_32x32x16_bf16 v[96:111], v[168:171], v[144:147], v[96:111]
    s_waitcnt vmcnt(22) lgkmcnt(0)
    ds_read_b64_tr_b16 a[216:217], v7 offset:6144
    ds_read_b64_tr_b16 a[218:219], v7 offset:7168
    ds_read_b64_tr_b16 a[220:221], v5 offset:6144
    ds_read_b64_tr_b16 a[222:223], v5 offset:7168
    v_exp_f32 v141, v141
    v_exp_f32 v142, v142
    v_exp_f32 v143, v143
    v_cvt_pk_bf16_f32 v148, v136, v137
    v_cvt_pk_bf16_f32 v149, v138, v139
    v_cvt_pk_bf16_f32 v150, v140, v141
    v_cvt_pk_bf16_f32 v151, v142, v143
    v_mfma_f32_32x32x16_bf16 v[128:143], v[176:179], v[24:27], 0
    buffer_load_dwordx4 v153, s[20:23], s58 offen offset:2048 lds
    v_exp_f32 v112, v112
    v_exp_f32 v113, v113
    v_exp_f32 v114, v114
    v_exp_f32 v115, v115
    v_exp_f32_e64 v116, v116
    v_mfma_f32_32x32x16_bf16 v[96:111], v[172:175], v[148:151], v[96:111]
    buffer_load_dwordx4 v[168:171], v2, s[28:31], s69 offen offset:2048 sc1
    buffer_load_dwordx4 v[172:175], v2, s[28:31], s69 offen offset:3072 sc1
    v_exp_f32 v117, v117
    v_exp_f32 v118, v118
    v_exp_f32_e64 v119, v119
    v_cvt_pk_bf16_f32 v144, v112, v113
    v_cvt_pk_bf16_f32 v145, v114, v115
    v_cvt_pk_bf16_f32 v146, v116, v117
    v_cvt_pk_bf16_f32 v147, v118, v119
    v_mfma_f32_32x32x16_bf16 v[128:143], v[180:183], v[28:31], v[128:143]
    buffer_load_dwordx4 v154, s[20:23], s58 offen offset:3072 lds
    v_exp_f32 v120, v120
    v_exp_f32 v121, v121
    v_exp_f32 v122, v122
    v_exp_f32 v123, v123
    v_exp_f32 v124, v124
    s_waitcnt vmcnt(24)
    v_mfma_f32_32x32x16_bf16 v[48:63], v[184:187], v[144:147], v[48:63]
    s_add_u32 m0, s67, 8192
    v_exp_f32 v125, v125
    v_exp_f32 v126, v126
    v_exp_f32_e64 v127, v127
    v_cvt_pk_bf16_f32 v148, v120, v121
    v_cvt_pk_bf16_f32 v149, v122, v123
    v_cvt_pk_bf16_f32 v150, v124, v125
    v_cvt_pk_bf16_f32 v151, v126, v127
    v_mfma_f32_32x32x16_bf16 v[112:127], v[176:179], v[32:35], 0
    s_add_u32 s58, s73, 229376
    v_exp_f32 v128, v128
    v_exp_f32 v129, v129
    v_exp_f32 v130, v130
    v_exp_f32 v131, v131
    v_exp_f32_e64 v132, v132
    v_mfma_f32_32x32x16_bf16 v[48:63], v[188:191], v[148:151], v[48:63]
    buffer_load_dwordx4 v6, s[20:23], s58 offen offset:0 lds
    v_exp_f32 v133, v133
    v_exp_f32 v134, v134
    v_exp_f32_e64 v135, v135
    v_cvt_pk_bf16_f32 v144, v128, v129
    v_cvt_pk_bf16_f32 v145, v130, v131
    v_cvt_pk_bf16_f32 v146, v132, v133
    v_cvt_pk_bf16_f32 v147, v134, v135
    v_mfma_f32_32x32x16_bf16 v[112:127], v[180:183], v[36:39], v[112:127]
    buffer_load_dwordx4 v152, s[20:23], s58 offen offset:1024 lds
    v_exp_f32 v136, v136
    v_exp_f32 v137, v137
    v_exp_f32 v138, v138
    v_exp_f32 v139, v139
    v_exp_f32_e64 v140, v140
    v_mfma_f32_32x32x16_bf16 v[64:79], v[184:187], v[144:147], v[64:79]
    buffer_load_dwordx4 v153, s[20:23], s58 offen offset:2048 lds
    v_exp_f32 v141, v141
    v_exp_f32 v142, v142
    v_exp_f32_e64 v143, v143
    v_cvt_pk_bf16_f32 v148, v136, v137
    v_cvt_pk_bf16_f32 v149, v138, v139
    v_cvt_pk_bf16_f32 v150, v140, v141
    v_cvt_pk_bf16_f32 v151, v142, v143
    v_mfma_f32_32x32x16_bf16 v[128:143], v[176:179], v[40:43], 0
    buffer_load_dwordx4 v154, s[20:23], s58 offen offset:3072 lds
    v_exp_f32 v112, v112
    v_exp_f32 v113, v113
    v_exp_f32 v114, v114
    v_exp_f32 v115, v115
    v_exp_f32_e64 v116, v116
    v_mfma_f32_32x32x16_bf16 v[64:79], v[188:191], v[148:151], v[64:79]
    s_add_u32 m0, s67, 12288
    v_exp_f32 v117, v117
    v_exp_f32 v118, v118
    v_exp_f32_e64 v119, v119
    v_cvt_pk_bf16_f32 v144, v112, v113
    v_cvt_pk_bf16_f32 v145, v114, v115
    v_cvt_pk_bf16_f32 v146, v116, v117
    v_cvt_pk_bf16_f32 v147, v118, v119
    v_mfma_f32_32x32x16_bf16 v[128:143], v[180:183], v[44:47], v[128:143]
    s_add_u32 s58, s73, 344064
    v_exp_f32 v120, v120
    v_exp_f32 v121, v121
    v_exp_f32 v122, v122
    v_exp_f32 v123, v123
    v_exp_f32_e64 v124, v124
    v_mfma_f32_32x32x16_bf16 v[80:95], v[184:187], v[144:147], v[80:95]
    buffer_load_dwordx4 v6, s[20:23], s58 offen offset:0 lds
    v_exp_f32 v125, v125
    v_exp_f32 v126, v126
    v_exp_f32_e64 v127, v127
    v_cvt_pk_bf16_f32 v148, v120, v121
    v_cvt_pk_bf16_f32 v149, v122, v123
    v_cvt_pk_bf16_f32 v150, v124, v125
    v_cvt_pk_bf16_f32 v151, v126, v127
    s_waitcnt vmcnt(23)
    v_mfma_f32_32x32x16_bf16 v[112:127], v[192:195], v[16:19], 0
    buffer_load_dwordx4 v152, s[20:23], s58 offen offset:1024 lds
    v_exp_f32 v128, v128
    v_exp_f32 v129, v129
    v_exp_f32 v130, v130
    v_exp_f32 v131, v131
    v_exp_f32 v132, v132
    v_mfma_f32_32x32x16_bf16 v[80:95], v[188:191], v[148:151], v[80:95]
    buffer_load_dwordx4 v153, s[20:23], s58 offen offset:2048 lds
    v_exp_f32 v133, v133
    v_exp_f32 v134, v134
    v_exp_f32_e64 v135, v135
    v_cvt_pk_bf16_f32 v144, v128, v129
    v_cvt_pk_bf16_f32 v145, v130, v131
    v_cvt_pk_bf16_f32 v146, v132, v133
    v_cvt_pk_bf16_f32 v147, v134, v135
    v_mfma_f32_32x32x16_bf16 v[112:127], v[196:199], v[20:23], v[112:127]
    buffer_load_dwordx4 v154, s[20:23], s58 offen offset:3072 lds
    v_exp_f32 v136, v136
    v_exp_f32 v137, v137
    v_exp_f32 v138, v138
    v_exp_f32 v139, v139
    v_exp_f32_e64 v140, v140
    v_mfma_f32_32x32x16_bf16 v[96:111], v[184:187], v[144:147], v[96:111]
    s_add_u32 m0, s67, 16384
    v_exp_f32 v141, v141
    v_exp_f32 v142, v142
    v_exp_f32_e64 v143, v143
    v_cvt_pk_bf16_f32 v148, v136, v137
    v_cvt_pk_bf16_f32 v149, v138, v139
    v_cvt_pk_bf16_f32 v150, v140, v141
    v_cvt_pk_bf16_f32 v151, v142, v143
    v_mfma_f32_32x32x16_bf16 v[128:143], v[192:195], v[24:27], 0
    s_add_u32 s58, s73, 458752
    v_exp_f32 v112, v112
    v_exp_f32 v113, v113
    v_exp_f32 v114, v114
    v_exp_f32 v115, v115
    v_exp_f32_e64 v116, v116
    v_mfma_f32_32x32x16_bf16 v[96:111], v[188:191], v[148:151], v[96:111]
    buffer_load_dwordx4 v6, s[20:23], s58 offen offset:0 lds
    v_exp_f32 v117, v117
    v_exp_f32 v118, v118
    v_exp_f32_e64 v119, v119
    v_cvt_pk_bf16_f32 v144, v112, v113
    v_cvt_pk_bf16_f32 v145, v114, v115
    v_cvt_pk_bf16_f32 v146, v116, v117
    v_cvt_pk_bf16_f32 v147, v118, v119
    v_mfma_f32_32x32x16_bf16 v[128:143], v[196:199], v[28:31], v[128:143]
    buffer_load_dwordx4 v152, s[20:23], s58 offen offset:1024 lds
    v_exp_f32 v120, v120
    v_exp_f32 v121, v121
    v_exp_f32 v122, v122
    v_exp_f32 v123, v123
    v_exp_f32 v124, v124
    s_waitcnt vmcnt(22)
    v_mfma_f32_32x32x16_bf16 v[48:63], v[200:203], v[144:147], v[48:63]
    buffer_load_dwordx4 v153, s[20:23], s58 offen offset:2048 lds
    v_exp_f32 v125, v125
    v_exp_f32 v126, v126
    v_exp_f32_e64 v127, v127
    v_cvt_pk_bf16_f32 v148, v120, v121
    v_cvt_pk_bf16_f32 v149, v122, v123
    v_cvt_pk_bf16_f32 v150, v124, v125
    v_cvt_pk_bf16_f32 v151, v126, v127
    v_mfma_f32_32x32x16_bf16 v[112:127], v[192:195], v[32:35], 0
    buffer_load_dwordx4 v154, s[20:23], s58 offen offset:3072 lds
    v_exp_f32 v128, v128
    v_exp_f32 v129, v129
    v_exp_f32 v130, v130
    v_exp_f32 v131, v131
    v_exp_f32_e64 v132, v132
    v_mfma_f32_32x32x16_bf16 v[48:63], v[204:207], v[148:151], v[48:63]
    v_exp_f32 v133, v133
    v_exp_f32 v134, v134
    v_exp_f32_e64 v135, v135
    v_cvt_pk_bf16_f32 v144, v128, v129
    v_cvt_pk_bf16_f32 v145, v130, v131
    v_cvt_pk_bf16_f32 v146, v132, v133
    v_cvt_pk_bf16_f32 v147, v134, v135
    v_mfma_f32_32x32x16_bf16 v[112:127], v[196:199], v[36:39], v[112:127]
    v_exp_f32 v136, v136
    v_exp_f32 v137, v137
    v_exp_f32 v138, v138
    v_exp_f32 v139, v139
    v_exp_f32_e64 v140, v140
    v_mfma_f32_32x32x16_bf16 v[64:79], v[200:203], v[144:147], v[64:79]
    v_exp_f32 v141, v141
    v_exp_f32 v142, v142
    v_exp_f32_e64 v143, v143
    v_cvt_pk_bf16_f32 v148, v136, v137
    v_cvt_pk_bf16_f32 v149, v138, v139
    v_cvt_pk_bf16_f32 v150, v140, v141
    v_cvt_pk_bf16_f32 v151, v142, v143
    v_mfma_f32_32x32x16_bf16 v[128:143], v[192:195], v[40:43], 0
    v_exp_f32 v112, v112
    v_exp_f32 v113, v113
    v_exp_f32 v114, v114
    v_exp_f32 v115, v115
    v_exp_f32_e64 v116, v116
    v_mfma_f32_32x32x16_bf16 v[64:79], v[204:207], v[148:151], v[64:79]
    v_exp_f32 v117, v117
    v_exp_f32 v118, v118
    v_exp_f32_e64 v119, v119
    v_cvt_pk_bf16_f32 v144, v112, v113
    v_cvt_pk_bf16_f32 v145, v114, v115
    v_cvt_pk_bf16_f32 v146, v116, v117
    v_cvt_pk_bf16_f32 v147, v118, v119
    v_mfma_f32_32x32x16_bf16 v[128:143], v[196:199], v[44:47], v[128:143]
    v_exp_f32 v120, v120
    v_exp_f32 v121, v121
    v_exp_f32 v122, v122
    v_exp_f32 v123, v123
    v_exp_f32_e64 v124, v124
    v_mfma_f32_32x32x16_bf16 v[80:95], v[200:203], v[144:147], v[80:95]
    v_exp_f32 v125, v125
    v_exp_f32 v126, v126
    v_exp_f32_e64 v127, v127
    v_cvt_pk_bf16_f32 v148, v120, v121
    v_cvt_pk_bf16_f32 v149, v122, v123
    v_cvt_pk_bf16_f32 v150, v124, v125
    v_cvt_pk_bf16_f32 v151, v126, v127
    s_waitcnt vmcnt(18)
    v_mfma_f32_32x32x16_bf16 v[112:127], v[160:163], v[24:27], 0
    v_exp_f32 v128, v128
    v_exp_f32 v129, v129
    v_exp_f32 v130, v130
    v_exp_f32 v131, v131
    v_exp_f32 v132, v132
    v_mfma_f32_32x32x16_bf16 v[80:95], v[204:207], v[148:151], v[80:95]
    v_exp_f32 v133, v133
    v_exp_f32 v134, v134
    v_exp_f32_e64 v135, v135
    v_cvt_pk_bf16_f32 v144, v128, v129
    v_cvt_pk_bf16_f32 v145, v130, v131
    v_cvt_pk_bf16_f32 v146, v132, v133
    v_cvt_pk_bf16_f32 v147, v134, v135
    v_mfma_f32_32x32x16_bf16 v[112:127], v[164:167], v[28:31], v[112:127]
    v_exp_f32 v136, v136
    v_exp_f32 v137, v137
    v_exp_f32 v138, v138
    v_exp_f32 v139, v139
    v_exp_f32_e64 v140, v140
    v_mfma_f32_32x32x16_bf16 v[96:111], v[200:203], v[144:147], v[96:111]
    v_exp_f32 v141, v141
    v_exp_f32 v142, v142
    v_exp_f32_e64 v143, v143
    v_cvt_pk_bf16_f32 v148, v136, v137
    v_cvt_pk_bf16_f32 v149, v138, v139
    v_cvt_pk_bf16_f32 v150, v140, v141
    v_cvt_pk_bf16_f32 v151, v142, v143
    v_mfma_f32_32x32x16_bf16 v[128:143], v[160:163], v[32:35], 0
    v_exp_f32 v112, v112
    v_exp_f32 v113, v113
    v_exp_f32 v114, v114
    v_exp_f32 v115, v115
    v_exp_f32_e64 v116, v116
    v_mfma_f32_32x32x16_bf16 v[96:111], v[204:207], v[148:151], v[96:111]
    v_exp_f32 v117, v117
    v_exp_f32 v118, v118
    v_exp_f32_e64 v119, v119
    v_cvt_pk_bf16_f32 v144, v112, v113
    v_cvt_pk_bf16_f32 v145, v114, v115
    v_cvt_pk_bf16_f32 v146, v116, v117
    v_cvt_pk_bf16_f32 v147, v118, v119
    v_mfma_f32_32x32x16_bf16 v[128:143], v[164:167], v[36:39], v[128:143]
    v_exp_f32 v120, v120
    v_exp_f32 v121, v121
    v_exp_f32 v122, v122
    v_exp_f32 v123, v123
    v_exp_f32 v124, v124
    s_waitcnt vmcnt(13)
    v_mfma_f32_32x32x16_bf16 v[64:79], v[168:171], v[144:147], v[64:79]
    v_exp_f32 v125, v125
    v_exp_f32 v126, v126
    v_exp_f32_e64 v127, v127
    v_cvt_pk_bf16_f32 v148, v120, v121
    v_cvt_pk_bf16_f32 v149, v122, v123
    v_cvt_pk_bf16_f32 v150, v124, v125
    v_cvt_pk_bf16_f32 v151, v126, v127
    v_mfma_f32_32x32x16_bf16 v[112:127], v[160:163], v[40:43], 0
    v_exp_f32 v128, v128
    v_exp_f32 v129, v129
    v_exp_f32 v130, v130
    v_exp_f32 v131, v131
    v_exp_f32_e64 v132, v132
    v_mfma_f32_32x32x16_bf16 v[64:79], v[172:175], v[148:151], v[64:79]
    v_exp_f32 v133, v133
    v_exp_f32 v134, v134
    v_exp_f32_e64 v135, v135
    v_cvt_pk_bf16_f32 v144, v128, v129
    v_cvt_pk_bf16_f32 v145, v130, v131
    v_cvt_pk_bf16_f32 v146, v132, v133
    v_cvt_pk_bf16_f32 v147, v134, v135
    v_mfma_f32_32x32x16_bf16 v[112:127], v[164:167], v[44:47], v[112:127]
    v_exp_f32 v136, v136
    v_exp_f32 v137, v137
    v_exp_f32 v138, v138
    v_exp_f32 v139, v139
    v_exp_f32_e64 v140, v140
    v_mfma_f32_32x32x16_bf16 v[80:95], v[168:171], v[144:147], v[80:95]
    s_waitcnt lgkmcnt(0)
    ds_write_b128 v10, v[64:67] offset:0
    ds_write_b128 v10, v[68:71] offset:1024
    ds_write_b128 v10, v[72:75] offset:2048
    ds_write_b128 v10, v[76:79] offset:3072
    v_exp_f32 v141, v141
    v_exp_f32 v142, v142
    v_exp_f32 v143, v143
    v_cvt_pk_bf16_f32 v148, v136, v137
    v_cvt_pk_bf16_f32 v149, v138, v139
    v_cvt_pk_bf16_f32 v150, v140, v141
    v_cvt_pk_bf16_f32 v151, v142, v143
    v_mfma_f32_32x32x16_bf16 v[128:143], v[160:163], v[16:19], 0
    v_exp_f32 v112, v112
    v_exp_f32 v113, v113
    v_exp_f32 v114, v114
    v_exp_f32 v115, v115
    v_exp_f32_e64 v116, v116
    v_mfma_f32_32x32x16_bf16 v[80:95], v[172:175], v[148:151], v[80:95]
    v_exp_f32 v117, v117
    v_exp_f32 v118, v118
    v_exp_f32_e64 v119, v119
    v_cvt_pk_bf16_f32 v144, v112, v113
    v_cvt_pk_bf16_f32 v145, v114, v115
    v_cvt_pk_bf16_f32 v146, v116, v117
    v_cvt_pk_bf16_f32 v147, v118, v119
    v_mfma_f32_32x32x16_bf16 v[128:143], v[164:167], v[20:23], v[128:143]
    v_exp_f32 v120, v120
    v_exp_f32 v121, v121
    v_exp_f32 v122, v122
    v_exp_f32 v123, v123
    v_exp_f32_e64 v124, v124
    v_mfma_f32_32x32x16_bf16 v[96:111], v[168:171], v[144:147], v[96:111]
    ds_write_b128 v10, v[80:83] offset:4096
    ds_write_b128 v10, v[84:87] offset:5120
    ds_write_b128 v10, v[88:91] offset:6144
    ds_write_b128 v10, v[92:95] offset:7168
    v_exp_f32 v125, v125
    v_exp_f32 v126, v126
    v_exp_f32_e64 v127, v127
    v_cvt_pk_bf16_f32 v148, v120, v121
    v_cvt_pk_bf16_f32 v149, v122, v123
    v_cvt_pk_bf16_f32 v150, v124, v125
    v_cvt_pk_bf16_f32 v151, v126, v127
    v_exp_f32 v128, v128
    v_exp_f32 v129, v129
    v_exp_f32 v130, v130
    v_exp_f32 v131, v131
    v_exp_f32_e64 v132, v132
    v_mfma_f32_32x32x16_bf16 v[96:111], v[172:175], v[148:151], v[96:111]
    v_exp_f32 v133, v133
    v_exp_f32 v134, v134
    v_exp_f32_e64 v135, v135
    v_cvt_pk_bf16_f32 v144, v128, v129
    v_cvt_pk_bf16_f32 v145, v130, v131
    v_cvt_pk_bf16_f32 v146, v132, v133
    v_cvt_pk_bf16_f32 v147, v134, v135
    v_exp_f32 v136, v136
    v_exp_f32 v137, v137
    v_exp_f32 v138, v138
    v_exp_f32 v139, v139
    v_exp_f32_e64 v140, v140
    v_mfma_f32_32x32x16_bf16 v[48:63], v[168:171], v[144:147], v[48:63]
    ds_write_b128 v10, v[96:99] offset:8192
    ds_write_b128 v10, v[100:103] offset:9216
    ds_write_b128 v10, v[104:107] offset:10240
    ds_write_b128 v10, v[108:111] offset:11264
    v_exp_f32 v141, v141
    v_exp_f32 v142, v142
    v_exp_f32_e64 v143, v143
    v_cvt_pk_bf16_f32 v148, v136, v137
    v_cvt_pk_bf16_f32 v149, v138, v139
    v_cvt_pk_bf16_f32 v150, v140, v141
    v_cvt_pk_bf16_f32 v151, v142, v143
    s_nop 1
    v_mfma_f32_32x32x16_bf16 v[48:63], v[172:175], v[148:151], v[48:63]
    s_waitcnt vmcnt(0) lgkmcnt(0)
    s_barrier
    ds_read_b128 v[64:67], v11 offset:0
    ds_read_b128 v[68:71], v11 offset:1024
    ds_read_b128 v[72:75], v11 offset:2048
    ds_read_b128 v[76:79], v11 offset:3072
    ds_read_b128 v[80:83], v12 offset:0
    ds_read_b128 v[84:87], v12 offset:1024
    ds_read_b128 v[88:91], v12 offset:2048
    ds_read_b128 v[92:95], v12 offset:3072
    ds_read_b128 v[96:99], v13 offset:0
    ds_read_b128 v[100:103], v13 offset:1024
    ds_read_b128 v[104:107], v13 offset:2048
    ds_read_b128 v[108:111], v13 offset:3072
    s_lshl_b32 s56, s49, 2
    s_add_u32 s56, s56, s3
    s_lshl_b32 s56, s56, 4
    s_add_u32 s56, s56, s48
    s_lshl_b32 s6, s56, 11
    s_add_u32 s6, s6, 5242880
    s_lshl_b32 s7, s56, 7
    s_add_u32 s7, s7, 131072
    v_mov_b32 v154, 0
    v_mov_b32_e64 v155, 0
    v_mov_b32 v156, 0x71800000
    v_mov_b32 v157, 0x1f800000
    v_mov_b32 v176, s54
    v_mov_b32 v177, s55
    v_mov_b32_e64 v178, 0
    v_mov_b32 v179, 0x1000000
    s_waitcnt lgkmcnt(8)
    v_pk_add_f32 v[48:49], v[48:49], v[64:65]
    v_pk_add_f32 v[50:51], v[50:51], v[66:67]
    v_pk_add_f32 v[52:53], v[52:53], v[68:69]
    v_pk_add_f32 v[54:55], v[54:55], v[70:71]
    v_pk_add_f32 v[56:57], v[56:57], v[72:73]
    v_pk_add_f32 v[58:59], v[58:59], v[74:75]
    v_pk_add_f32 v[60:61], v[60:61], v[76:77]
    v_pk_add_f32 v[62:63], v[62:63], v[78:79]
    s_waitcnt lgkmcnt(4)
    v_pk_add_f32 v[48:49], v[48:49], v[80:81]
    v_pk_add_f32 v[50:51], v[50:51], v[82:83]
    v_pk_add_f32 v[52:53], v[52:53], v[84:85]
    v_pk_add_f32 v[54:55], v[54:55], v[86:87]
    v_pk_add_f32 v[56:57], v[56:57], v[88:89]
    v_pk_add_f32 v[58:59], v[58:59], v[90:91]
    v_pk_add_f32 v[60:61], v[60:61], v[92:93]
    v_pk_add_f32 v[62:63], v[62:63], v[94:95]
    s_waitcnt lgkmcnt(0)
    v_pk_add_f32 v[48:49], v[48:49], v[96:97]
    v_pk_add_f32 v[50:51], v[50:51], v[98:99]
    v_pk_add_f32 v[52:53], v[52:53], v[100:101]
    v_pk_add_f32 v[54:55], v[54:55], v[102:103]
    v_pk_add_f32 v[56:57], v[56:57], v[104:105]
    v_pk_add_f32 v[58:59], v[58:59], v[106:107]
    v_pk_add_f32 v[60:61], v[60:61], v[108:109]
    v_pk_add_f32 v[62:63], v[62:63], v[110:111]
    v_mov_b32 v152, v60
    v_mov_b32_e64 v153, v60
    s_nop 1
    v_permlane32_swap_b32 v152, v153
    v_pk_fma_f32 v[154:155], v[48:49], 0, v[154:155]
    v_pk_fma_f32 v[154:155], v[50:51], 0, v[154:155]
    v_pk_fma_f32 v[154:155], v[52:53], 0, v[154:155]
    v_pk_fma_f32 v[154:155], v[54:55], 0, v[154:155]
    v_pk_fma_f32 v[154:155], v[56:57], 0, v[154:155]
    v_pk_fma_f32 v[154:155], v[58:59], 0, v[154:155]
    v_pk_fma_f32 v[154:155], v[60:61], 0, v[154:155]
    v_pk_fma_f32 v[154:155], v[62:63], 0, v[154:155]
    v_cmp_lt_f32 s[4:5], v153, v156
    v_cmp_gt_f32 vcc, v153, v157
    s_nop 0
    s_and_b64 s[4:5], s[4:5], vcc
    v_cmp_o_f32 vcc, v154, v155
    s_nop 0
    s_and_b64 s[4:5], s[4:5], vcc
    s_cmp_eq_u64 s[4:5], -1
    s_cbranch_scc0 L_fallback
L_norm_6:
    v_rcp_f32 v152, v153
    s_nop 0
    v_pk_mul_f32 v[48:49], v[48:49], v[152:153] op_sel_hi:[1,0]
    v_pk_mul_f32 v[50:51], v[50:51], v[152:153] op_sel_hi:[1,0]
    v_pk_mul_f32 v[52:53], v[52:53], v[152:153] op_sel_hi:[1,0]
    v_pk_mul_f32 v[54:55], v[54:55], v[152:153] op_sel_hi:[1,0]
    v_pk_mul_f32 v[56:57], v[56:57], v[152:153] op_sel_hi:[1,0]
    v_pk_mul_f32 v[58:59], v[58:59], v[152:153] op_sel_hi:[1,0]
    v_pk_mul_f32 v[60:61], v[60:61], v[152:153] op_sel_hi:[1,0]
    v_pk_mul_f32 v[62:63], v[62:63], v[152:153] op_sel_hi:[1,0]
    v_cvt_pk_bf16_f32 v144, v48, v49
    v_cvt_pk_bf16_f32 v145, v50, v51
    v_cvt_pk_bf16_f32 v146, v52, v53
    v_cvt_pk_bf16_f32 v147, v54, v55
    buffer_store_dwordx4 v[144:147], v2, s[28:31], s6 offen sc1
    v_cvt_pk_bf16_f32 v148, v56, v57
    v_cvt_pk_bf16_f32 v149, v58, v59
    v_cvt_pk_bf16_f32 v150, v60, v61
    v_cvt_pk_bf16_f32 v151, v62, v63
    v_cndmask_b32 v150, v150, v178, s[60:61]
    v_cndmask_b32 v151, v151, v178, s[60:61]
    buffer_store_dwordx4 v[148:151], v2, s[28:31], s6 offen offset:1024 sc1
    s_mov_b32 s79, s7
    s_lshl_b32 s56, s50, 5
    s_lshl_b32 s57, s3, 2
    s_add_u32 s56, s56, s57
    s_lshl_b32 s56, s56, 7
    v_add_u32_e64 v192, s56, v14
    s_lshl_b32 s58, s64, 15
    s_lshl_b32 s57, s3, 13
    s_add_u32 s58, s58, s57
    s_add_u32 s58, s58, 5242880
    s_lshl_b32 s59, s65, 15
    s_lshl_b32 s57, s3, 13
    s_add_u32 s59, s59, s57
    s_add_u32 s59, s59, 5242880
    s_add_u32 s4, s58, 4096
    s_add_u32 s5, s59, 4096
    v_lshlrev_b32 v48, 16, v240
    v_and_b32 v49, 0xffff0000, v240
    v_lshlrev_b32_e64 v50, 16, v241
    v_and_b32 v51, 0xffff0000, v241
    v_lshlrev_b32_e64 v52, 16, v242
    v_and_b32 v53, 0xffff0000, v242
    v_lshlrev_b32_e64 v54, 16, v243
    v_and_b32 v55, 0xffff0000, v243
    v_lshlrev_b32_e64 v56, 16, v244
    v_and_b32 v57, 0xffff0000, v244
    v_lshlrev_b32_e64 v58, 16, v245
    v_and_b32 v59, 0xffff0000, v245
    v_lshlrev_b32_e64 v60, 16, v246
    v_and_b32 v61, 0xffff0000, v246
    v_lshlrev_b32_e64 v62, 16, v247
    v_and_b32 v63, 0xffff0000, v247
    s_lshl_b32 s6, s51, 1
    s_and_b32 s57, s3, 1
    s_add_u32 s6, s6, s57
    s_mul_i32 s7, s64, 14
    s_add_u32 s7, s7, s6
    s_lshl_b32 s7, s7, 8
    s_add_u32 s7, s7, 9175040
    s_lshl_b32 s57, s64, 4
    s_add_u32 s6, s6, s57
    s_lshl_b32 s6, s6, 7
    s_add_u32 s6, s6, 262144
    v_lshlrev_b32 v196, 3, v1
    v_mov_b32 v198, 0
    v_mov_b32 v199, 0
    v_mov_b32 v202, s54
    v_mov_b32 v203, s55
    v_mov_b32_e64 v204, 0
    v_mov_b32 v205, 0x1000000
    s_mov_b32 s56, 0x20000
    s_mov_b32 exec_lo, 0
    s_mov_b32 exec_hi, 0xff
    buffer_load_dwordx2 v[194:195], v192, s[28:31], s56 offen sc1
    s_mov_b64 exec, -1
    s_waitcnt vmcnt(1)
    s_mov_b64 exec, 1
    buffer_store_dwordx2 v[176:177], v178, s[28:31], s79 offen sc1
    s_mov_b64 exec, -1
    s_cmp_ge_u32 s2, 224
    s_cbranch_scc1 L_fin
    s_lshr_b32 s79, s3, 1
    s_mul_i32 s79, s79, 57344
    s_and_b32 s57, s3, 1
    s_lshl_b32 s57, s57, 6
    v_xor_b32 v193, s57, v8
    v_add_u32 v193, s79, v193
    v_mov_b32 v249, 0
    v_mov_b32_e64 v250, 0
    ds_read_b64_tr_b16 v[64:65], v193 offset:0
    ds_read_b64_tr_b16 v[66:67], v193 offset:1024
    ds_read_b64_tr_b16 v[68:69], v193 offset:2048
    ds_read_b64_tr_b16 v[70:71], v193 offset:3072
    ds_read_b64_tr_b16 v[72:73], v193 offset:4096
    ds_read_b64_tr_b16 v[74:75], v193 offset:5120
    ds_read_b64_tr_b16 v[76:77], v193 offset:6144
    ds_read_b64_tr_b16 v[78:79], v193 offset:7168
    ds_read_b64_tr_b16 v[80:81], v193 offset:8192
    ds_read_b64_tr_b16 v[82:83], v193 offset:9216
    ds_read_b64_tr_b16 v[84:85], v193 offset:10240
    ds_read_b64_tr_b16 v[86:87], v193 offset:11264
    ds_read_b64_tr_b16 v[88:89], v193 offset:12288
    ds_read_b64_tr_b16 v[90:91], v193 offset:13312
    s_waitcnt lgkmcnt(0)
    ds_read_b64_tr_b16 v[92:93], v193 offset:14336
    ds_read_b64_tr_b16 v[94:95], v193 offset:15360
    ds_read_b64_tr_b16 v[96:97], v193 offset:16384
    ds_read_b64_tr_b16 v[98:99], v193 offset:17408
    ds_read_b64_tr_b16 v[100:101], v193 offset:18432
    ds_read_b64_tr_b16 v[102:103], v193 offset:19456
    ds_read_b64_tr_b16 v[104:105], v193 offset:20480
    ds_read_b64_tr_b16 v[106:107], v193 offset:21504
    ds_read_b64_tr_b16 v[108:109], v193 offset:22528
    ds_read_b64_tr_b16 v[110:111], v193 offset:23552
    ds_read_b64_tr_b16 v[112:113], v193 offset:24576
    ds_read_b64_tr_b16 v[114:115], v193 offset:25600
    ds_read_b64_tr_b16 v[116:117], v193 offset:26624
    ds_read_b64_tr_b16 v[118:119], v193 offset:27648
    v_dot2c_f32_bf16 v249, s68, v64
    v_dot2c_f32_bf16 v250, s68, v65
    v_dot2c_f32_bf16 v249, s68, v66
    v_dot2c_f32_bf16 v250, s68, v67
    v_dot2c_f32_bf16 v249, s68, v68
    v_dot2c_f32_bf16 v250, s68, v69
    v_dot2c_f32_bf16 v249, s68, v70
    v_dot2c_f32_bf16 v250, s68, v71
    v_dot2c_f32_bf16 v249, s68, v72
    v_dot2c_f32_bf16 v250, s68, v73
    v_dot2c_f32_bf16 v249, s68, v74
    v_dot2c_f32_bf16 v250, s68, v75
    v_dot2c_f32_bf16 v249, s68, v76
    v_dot2c_f32_bf16 v250, s68, v77
    v_dot2c_f32_bf16 v249, s68, v78
    v_dot2c_f32_bf16 v250, s68, v79
    v_dot2c_f32_bf16 v249, s68, v80
    v_dot2c_f32_bf16 v250, s68, v81
    v_dot2c_f32_bf16 v249, s68, v82
    v_dot2c_f32_bf16 v250, s68, v83
    v_dot2c_f32_bf16 v249, s68, v84
    v_dot2c_f32_bf16 v250, s68, v85
    v_dot2c_f32_bf16 v249, s68, v86
    v_dot2c_f32_bf16 v250, s68, v87
    v_dot2c_f32_bf16 v249, s68, v88
    v_dot2c_f32_bf16 v250, s68, v89
    v_dot2c_f32_bf16 v249, s68, v90
    v_dot2c_f32_bf16 v250, s68, v91
    s_waitcnt lgkmcnt(0)
    ds_read_b64_tr_b16 v[64:65], v193 offset:28672
    ds_read_b64_tr_b16 v[66:67], v193 offset:29696
    ds_read_b64_tr_b16 v[68:69], v193 offset:30720
    ds_read_b64_tr_b16 v[70:71], v193 offset:31744
    ds_read_b64_tr_b16 v[72:73], v193 offset:32768
    ds_read_b64_tr_b16 v[74:75], v193 offset:33792
    ds_read_b64_tr_b16 v[76:77], v193 offset:34816
    ds_read_b64_tr_b16 v[78:79], v193 offset:35840
    ds_read_b64_tr_b16 v[80:81], v193 offset:36864
    ds_read_b64_tr_b16 v[82:83], v193 offset:37888
    ds_read_b64_tr_b16 v[84:85], v193 offset:38912
    ds_read_b64_tr_b16 v[86:87], v193 offset:39936
    ds_read_b64_tr_b16 v[88:89], v193 offset:40960
    ds_read_b64_tr_b16 v[90:91], v193 offset:41984
    v_dot2c_f32_bf16 v249, s68, v92
    v_dot2c_f32_bf16 v250, s68, v93
    v_dot2c_f32_bf16 v249, s68, v94
    v_dot2c_f32_bf16 v250, s68, v95
    v_dot2c_f32_bf16 v249, s68, v96
    v_dot2c_f32_bf16 v250, s68, v97
    v_dot2c_f32_bf16 v249, s68, v98
    v_dot2c_f32_bf16 v250, s68, v99
    v_dot2c_f32_bf16 v249, s68, v100
    v_dot2c_f32_bf16 v250, s68, v101
    v_dot2c_f32_bf16 v249, s68, v102
    v_dot2c_f32_bf16 v250, s68, v103
    v_dot2c_f32_bf16 v249, s68, v104
    v_dot2c_f32_bf16 v250, s68, v105
    v_dot2c_f32_bf16 v249, s68, v106
    v_dot2c_f32_bf16 v250, s68, v107
    v_dot2c_f32_bf16 v249, s68, v108
    v_dot2c_f32_bf16 v250, s68, v109
    v_dot2c_f32_bf16 v249, s68, v110
    v_dot2c_f32_bf16 v250, s68, v111
    v_dot2c_f32_bf16 v249, s68, v112
    v_dot2c_f32_bf16 v250, s68, v113
    v_dot2c_f32_bf16 v249, s68, v114
    v_dot2c_f32_bf16 v250, s68, v115
    v_dot2c_f32_bf16 v249, s68, v116
    v_dot2c_f32_bf16 v250, s68, v117
    v_dot2c_f32_bf16 v249, s68, v118
    v_dot2c_f32_bf16 v250, s68, v119
    s_mov_b32 exec_lo, 0
    s_mov_b32 exec_hi, 0xff
    buffer_load_dwordx2 v[194:195], v192, s[28:31], s56 offen sc1
    s_mov_b64 exec, -1
    s_waitcnt lgkmcnt(0)
    ds_read_b64_tr_b16 v[92:93], v193 offset:43008
    ds_read_b64_tr_b16 v[94:95], v193 offset:44032
    ds_read_b64_tr_b16 v[96:97], v193 offset:45056
    ds_read_b64_tr_b16 v[98:99], v193 offset:46080
    ds_read_b64_tr_b16 v[100:101], v193 offset:47104
    ds_read_b64_tr_b16 v[102:103], v193 offset:48128
    ds_read_b64_tr_b16 v[104:105], v193 offset:49152
    ds_read_b64_tr_b16 v[106:107], v193 offset:50176
    ds_read_b64_tr_b16 v[108:109], v193 offset:51200
    ds_read_b64_tr_b16 v[110:111], v193 offset:52224
    ds_read_b64_tr_b16 v[112:113], v193 offset:53248
    ds_read_b64_tr_b16 v[114:115], v193 offset:54272
    ds_read_b64_tr_b16 v[116:117], v193 offset:55296
    ds_read_b64_tr_b16 v[118:119], v193 offset:56320
    v_dot2c_f32_bf16 v249, s68, v64
    v_dot2c_f32_bf16 v250, s68, v65
    v_dot2c_f32_bf16 v249, s68, v66
    v_dot2c_f32_bf16 v250, s68, v67
    v_dot2c_f32_bf16 v249, s68, v68
    v_dot2c_f32_bf16 v250, s68, v69
    v_dot2c_f32_bf16 v249, s68, v70
    v_dot2c_f32_bf16 v250, s68, v71
    v_dot2c_f32_bf16 v249, s68, v72
    v_dot2c_f32_bf16 v250, s68, v73
    v_dot2c_f32_bf16 v249, s68, v74
    v_dot2c_f32_bf16 v250, s68, v75
    v_dot2c_f32_bf16 v249, s68, v76
    v_dot2c_f32_bf16 v250, s68, v77
    v_dot2c_f32_bf16 v249, s68, v78
    v_dot2c_f32_bf16 v250, s68, v79
    v_dot2c_f32_bf16 v249, s68, v80
    v_dot2c_f32_bf16 v250, s68, v81
    v_dot2c_f32_bf16 v249, s68, v82
    v_dot2c_f32_bf16 v250, s68, v83
    v_dot2c_f32_bf16 v249, s68, v84
    v_dot2c_f32_bf16 v250, s68, v85
    v_dot2c_f32_bf16 v249, s68, v86
    v_dot2c_f32_bf16 v250, s68, v87
    v_dot2c_f32_bf16 v249, s68, v88
    v_dot2c_f32_bf16 v250, s68, v89
    v_dot2c_f32_bf16 v249, s68, v90
    v_dot2c_f32_bf16 v250, s68, v91
    s_waitcnt lgkmcnt(0)
    v_dot2c_f32_bf16 v249, s68, v92
    v_dot2c_f32_bf16 v250, s68, v93
    v_dot2c_f32_bf16 v249, s68, v94
    v_dot2c_f32_bf16 v250, s68, v95
    v_dot2c_f32_bf16 v249, s68, v96
    v_dot2c_f32_bf16 v250, s68, v97
    v_dot2c_f32_bf16 v249, s68, v98
    v_dot2c_f32_bf16 v250, s68, v99
    v_dot2c_f32_bf16 v249, s68, v100
    v_dot2c_f32_bf16 v250, s68, v101
    v_dot2c_f32_bf16 v249, s68, v102
    v_dot2c_f32_bf16 v250, s68, v103
    v_dot2c_f32_bf16 v249, s68, v104
    v_dot2c_f32_bf16 v250, s68, v105
    v_dot2c_f32_bf16 v249, s68, v106
    v_dot2c_f32_bf16 v250, s68, v107
    v_dot2c_f32_bf16 v249, s68, v108
    v_dot2c_f32_bf16 v250, s68, v109
    v_dot2c_f32_bf16 v249, s68, v110
    v_dot2c_f32_bf16 v250, s68, v111
    v_dot2c_f32_bf16 v249, s68, v112
    v_dot2c_f32_bf16 v250, s68, v113
    v_dot2c_f32_bf16 v249, s68, v114
    v_dot2c_f32_bf16 v250, s68, v115
    v_dot2c_f32_bf16 v249, s68, v116
    v_dot2c_f32_bf16 v250, s68, v117
    v_dot2c_f32_bf16 v249, s68, v118
    v_dot2c_f32_bf16 v250, s68, v119
    s_nop 2
    v_add_f32 v249, v249, v250
    v_mov_b32 v250, v249
    s_nop 1
    v_permlane32_swap_b32 v249, v250
    v_add_f32 v249, v249, v250
    v_cvt_pk_bf16_f32 v250, v249, v249
    v_lshlrev_b32 v250, 16, v250
    v_sub_f32 v250, v249, v250
    v_cvt_pk_bf16_f32 v249, v249, v250
    v_lshl_or_b32 v248, v248, 16, v248
    s_barrier
    v_mov_b32 v64, v249
    v_mov_b32 v65, v249
    v_mov_b32 v66, v248
    v_mov_b32_e64 v67, 0
    ds_write_b128 v10, v[64:67] offset:10240
    v_add_u32 v68, 124928, v2
    s_waitcnt lgkmcnt(0)
    s_barrier
    ds_read_b128 v[176:179], v68 offset:0
    ds_read_b128 v[180:183], v68 offset:12288
    ds_read_b128 v[184:187], v68 offset:24576
    ds_read_b128 v[188:191], v68 offset:36864
    s_waitcnt lgkmcnt(0)
    s_barrier
    s_waitcnt vmcnt(0)
    v_cmp_eq_u64 vcc, s[54:55], v[194:195]
    s_nop 0
    s_and_b32 vcc_hi, vcc_hi, 0xff
    s_cmp_eq_u32 vcc_hi, 0xff
    s_cbranch_scc1 L_bok_7
    s_mov_b32 exec_lo, 0x0
    s_mov_b32 exec_hi, 0xff
    s_mov_b32 s56, 0x20000
    s_mov_b32 s74, 0x400000
L_poll_8:
    buffer_load_dwordx2 v[194:195], v192, s[28:31], s56 offen sc1
    s_sub_u32 s74, s74, 1
    s_cbranch_scc1 L_pollok_9
    s_waitcnt vmcnt(0)
    v_cmp_ne_u64 vcc, s[54:55], v[194:195]
    s_cbranch_vccnz L_poll_8
L_pollok_9:
    s_waitcnt vmcnt(0)
    s_mov_b64 exec, -1
L_bok_7:
    buffer_load_dwordx4 v[116:119], v2, s[28:31], s59 offen offset:0 sc1
    buffer_load_dwordx4 v[124:127], v2, s[28:31], s59 offen offset:1024 sc1
    buffer_load_dwordx4 v[132:135], v2, s[28:31], s59 offen offset:2048 sc1
    buffer_load_dwordx4 v[140:143], v2, s[28:31], s59 offen offset:3072 sc1
    buffer_load_dwordx4 v[148:151], v2, s[28:31], s5 offen offset:0 sc1
    buffer_load_dwordx4 v[156:159], v2, s[28:31], s5 offen offset:1024 sc1
    buffer_load_dwordx4 v[164:167], v2, s[28:31], s5 offen offset:2048 sc1
    buffer_load_dwordx4 v[172:175], v2, s[28:31], s5 offen offset:3072 sc1
    buffer_load_dwordx4 v[112:115], v2, s[28:31], s58 offen offset:0 sc1
    buffer_load_dwordx4 v[120:123], v2, s[28:31], s58 offen offset:1024 sc1
    buffer_load_dwordx4 v[128:131], v2, s[28:31], s58 offen offset:2048 sc1
    buffer_load_dwordx4 v[136:139], v2, s[28:31], s58 offen offset:3072 sc1
    buffer_load_dwordx4 v[144:147], v2, s[28:31], s4 offen offset:0 sc1
    buffer_load_dwordx4 v[152:155], v2, s[28:31], s4 offen offset:1024 sc1
    buffer_load_dwordx4 v[160:163], v2, s[28:31], s4 offen offset:2048 sc1
    buffer_load_dwordx4 v[168:171], v2, s[28:31], s4 offen offset:3072 sc1
    s_waitcnt vmcnt(15)
    v_mfma_f32_32x32x16_bf16 v[96:111], v[212:215], v[116:119], 0
    v_mfma_f32_32x32x16_bf16 v[80:95], v[208:211], v[116:119], 0
    s_waitcnt vmcnt(14)
    v_mfma_f32_32x32x16_bf16 v[96:111], v[220:223], v[124:127], v[96:111]
    v_mfma_f32_32x32x16_bf16 v[80:95], v[216:219], v[124:127], v[80:95]
    s_waitcnt vmcnt(13)
    v_mfma_f32_32x32x16_bf16 v[96:111], v[228:231], v[132:135], v[96:111]
    v_mfma_f32_32x32x16_bf16 v[80:95], v[224:227], v[132:135], v[80:95]
    s_waitcnt vmcnt(12)
    v_mfma_f32_32x32x16_bf16 v[96:111], v[236:239], v[140:143], v[96:111]
    v_mfma_f32_32x32x16_bf16 v[80:95], v[232:235], v[140:143], v[80:95]
    s_waitcnt vmcnt(11)
    v_mfma_f32_32x32x16_bf16 v[96:111], a[228:231], v[148:151], v[96:111]
    v_mfma_f32_32x32x16_bf16 v[80:95], a[224:227], v[148:151], v[80:95]
    s_waitcnt vmcnt(10)
    v_mfma_f32_32x32x16_bf16 v[96:111], a[236:239], v[156:159], v[96:111]
    v_mfma_f32_32x32x16_bf16 v[80:95], a[232:235], v[156:159], v[80:95]
    s_waitcnt vmcnt(9)
    v_mfma_f32_32x32x16_bf16 v[96:111], a[244:247], v[164:167], v[96:111]
    v_mfma_f32_32x32x16_bf16 v[80:95], a[240:243], v[164:167], v[80:95]
    s_waitcnt vmcnt(8)
    v_mfma_f32_32x32x16_bf16 v[96:111], a[252:255], v[172:175], v[96:111]
    v_mfma_f32_32x32x16_bf16 v[80:95], a[248:251], v[172:175], v[80:95]
    s_waitcnt vmcnt(7)
    v_mfma_f32_32x32x16_bf16 v[64:79], v[212:215], v[112:115], 0
    v_mfma_f32_32x32x16_bf16 v[48:63], v[208:211], v[112:115], v[48:63]
    s_waitcnt vmcnt(6)
    v_mfma_f32_32x32x16_bf16 v[64:79], v[220:223], v[120:123], v[64:79]
    v_mfma_f32_32x32x16_bf16 v[48:63], v[216:219], v[120:123], v[48:63]
    s_waitcnt vmcnt(5)
    v_mfma_f32_32x32x16_bf16 v[64:79], v[228:231], v[128:131], v[64:79]
    v_mfma_f32_32x32x16_bf16 v[48:63], v[224:227], v[128:131], v[48:63]
    s_waitcnt vmcnt(4)
    v_mfma_f32_32x32x16_bf16 v[64:79], v[236:239], v[136:139], v[64:79]
    ds_write_b128 v10, v[96:99] offset:8192
    v_mfma_f32_32x32x16_bf16 v[48:63], v[232:235], v[136:139], v[48:63]
    ds_write_b128 v10, v[100:103] offset:9216
    s_waitcnt vmcnt(3)
    v_mfma_f32_32x32x16_bf16 v[64:79], a[228:231], v[144:147], v[64:79]
    ds_write_b128 v10, v[104:107] offset:10240
    v_mfma_f32_32x32x16_bf16 v[48:63], a[224:227], v[144:147], v[48:63]
    ds_write_b128 v10, v[108:111] offset:11264
    s_waitcnt vmcnt(2)
    v_mfma_f32_32x32x16_bf16 v[64:79], a[236:239], v[152:155], v[64:79]
    ds_write_b128 v10, v[80:83] offset:4096
    v_mfma_f32_32x32x16_bf16 v[48:63], a[232:235], v[152:155], v[48:63]
    ds_write_b128 v10, v[84:87] offset:5120
    s_waitcnt vmcnt(1)
    v_mfma_f32_32x32x16_bf16 v[64:79], a[244:247], v[160:163], v[64:79]
    ds_write_b128 v10, v[88:91] offset:6144
    v_mfma_f32_32x32x16_bf16 v[48:63], a[240:243], v[160:163], v[48:63]
    ds_write_b128 v10, v[92:95] offset:7168
    s_waitcnt vmcnt(0)
    v_mfma_f32_32x32x16_bf16 v[64:79], a[252:255], v[168:171], v[64:79]
    v_mfma_f32_32x32x16_bf16 v[48:63], a[248:251], v[168:171], v[48:63]
    s_nop 10
    ds_write_b128 v10, v[64:67] offset:0
    ds_write_b128 v10, v[68:71] offset:1024
    ds_write_b128 v10, v[72:75] offset:2048
    ds_write_b128 v10, v[76:79] offset:3072
    s_waitcnt lgkmcnt(0)
    s_barrier
    ds_read_b128 v[96:99], v13 offset:0
    ds_read_b128 v[100:103], v13 offset:1024
    ds_read_b128 v[104:107], v13 offset:2048
    ds_read_b128 v[108:111], v13 offset:3072
    ds_read_b128 v[80:83], v12 offset:0
    ds_read_b128 v[84:87], v12 offset:1024
    ds_read_b128 v[88:91], v12 offset:2048
    ds_read_b128 v[92:95], v12 offset:3072
    ds_read_b128 v[64:67], v11 offset:0
    ds_read_b128 v[68:71], v11 offset:1024
    ds_read_b128 v[72:75], v11 offset:2048
    ds_read_b128 v[76:79], v11 offset:3072
    s_waitcnt lgkmcnt(8)
    v_pk_add_f32 v[48:49], v[48:49], v[96:97]
    v_pk_add_f32 v[50:51], v[50:51], v[98:99]
    v_pk_add_f32 v[52:53], v[52:53], v[100:101]
    v_pk_add_f32 v[54:55], v[54:55], v[102:103]
    v_pk_add_f32 v[56:57], v[56:57], v[104:105]
    v_pk_add_f32 v[58:59], v[58:59], v[106:107]
    v_pk_add_f32 v[60:61], v[60:61], v[108:109]
    v_pk_add_f32 v[62:63], v[62:63], v[110:111]
    s_waitcnt lgkmcnt(4)
    v_pk_add_f32 v[48:49], v[48:49], v[80:81]
    v_pk_add_f32 v[50:51], v[50:51], v[82:83]
    v_pk_add_f32 v[52:53], v[52:53], v[84:85]
    v_pk_add_f32 v[54:55], v[54:55], v[86:87]
    v_pk_add_f32 v[56:57], v[56:57], v[88:89]
    v_pk_add_f32 v[58:59], v[58:59], v[90:91]
    v_pk_add_f32 v[60:61], v[60:61], v[92:93]
    v_pk_add_f32 v[62:63], v[62:63], v[94:95]
    s_waitcnt lgkmcnt(0)
    v_pk_add_f32 v[48:49], v[48:49], v[64:65]
    v_pk_add_f32 v[50:51], v[50:51], v[66:67]
    v_pk_add_f32 v[52:53], v[52:53], v[68:69]
    v_pk_add_f32 v[54:55], v[54:55], v[70:71]
    v_pk_add_f32 v[56:57], v[56:57], v[72:73]
    v_pk_add_f32 v[58:59], v[58:59], v[74:75]
    v_pk_add_f32 v[60:61], v[60:61], v[76:77]
    v_pk_add_f32 v[62:63], v[62:63], v[78:79]
    v_cvt_pk_bf16_f32 v240, v48, v49
    v_cvt_pk_bf16_f32 v241, v50, v51
    v_cvt_pk_bf16_f32 v242, v52, v53
    v_cvt_pk_bf16_f32 v243, v54, v55
    buffer_store_dwordx4 v[240:243], v2, s[28:31], s66 offen sc1
    v_cvt_pk_bf16_f32 v244, v56, v57
    v_cvt_pk_bf16_f32 v245, v58, v59
    v_cvt_pk_bf16_f32 v246, v60, v61
    v_cvt_pk_bf16_f32 v247, v62, v63
    buffer_store_dwordx4 v[244:247], v2, s[28:31], s66 offen offset:1024 sc1
    v_dot2c_f32_bf16 v198, s68, v240
    v_dot2c_f32_bf16 v199, v240, v240
    v_dot2c_f32_bf16 v198, s68, v241
    v_dot2c_f32_bf16 v199, v241, v241
    v_dot2c_f32_bf16 v198, s68, v242
    v_dot2c_f32_bf16 v199, v242, v242
    v_dot2c_f32_bf16 v198, s68, v243
    v_dot2c_f32_bf16 v199, v243, v243
    v_dot2c_f32_bf16 v198, s68, v244
    v_dot2c_f32_bf16 v199, v244, v244
    v_dot2c_f32_bf16 v198, s68, v245
    v_dot2c_f32_bf16 v199, v245, v245
    v_dot2c_f32_bf16 v198, s68, v246
    v_dot2c_f32_bf16 v199, v246, v246
    v_dot2c_f32_bf16 v198, s68, v247
    v_dot2c_f32_bf16 v199, v247, v247
    s_nop 1
    v_mov_b32 v200, v198
    v_mov_b32 v201, v199
    s_nop 0
    v_permlane32_swap_b32 v198, v200
    v_permlane32_swap_b32 v199, v201
    v_pk_add_f32 v[198:199], v[198:199], v[200:201]
    s_mov_b64 exec, 0xffffffff
    buffer_store_dwordx2 v[198:199], v196, s[28:31], s7 offen sc1
    s_mov_b64 exec, -1
    s_lshl_b32 s69, s52, 2
    s_add_u32 s69, s69, s3
    s_lshl_b32 s56, s69, 11
    v_add_u32_e64 v232, s56, v9
    s_mul_i32 s58, s69, 28672
    s_add_u32 s58, s58, 7340032
    s_mul_i32 s59, s69, 3584
    s_add_u32 s59, s59, 9175040
    v_lshlrev_b32 v228, 3, v1
    v_xor_b32 v236, 64, v8
    s_waitcnt vmcnt(0)
    s_mov_b64 exec, 1
    buffer_store_dwordx2 v[202:203], v205, s[28:31], s6 offen
    s_mov_b32 s80, s6
    s_mov_b64 exec, -1
    ds_read_b64_tr_b16 v[192:193], v8 offset:0
    ds_read_b64_tr_b16 v[194:195], v8 offset:1024
    ds_read_b64_tr_b16 v[196:197], v236 offset:0
    ds_read_b64_tr_b16 v[198:199], v236 offset:1024
    ds_read_b64_tr_b16 v[200:201], v8 offset:2048
    ds_read_b64_tr_b16 v[202:203], v8 offset:3072
    ds_read_b64_tr_b16 v[204:205], v236 offset:2048
    ds_read_b64_tr_b16 v[206:207], v236 offset:3072
    s_mov_b32 exec_lo, 0x3fff
    s_mov_b32 exec_hi, 0
    s_mov_b32 s56, 0x40000
    s_mov_b32 s74, 30
L_poll_10:
    buffer_load_dwordx2 v[234:235], v232, s[28:31], s56 offen sc1
    s_waitcnt vmcnt(0)
    v_cmp_ne_u64 vcc, s[54:55], v[234:235]
    s_cbranch_vccz L_pollok_11
    s_sub_u32 s74, s74, 1
    s_cbranch_scc0 L_poll_10
    s_mov_b64 exec, 1
    v_mov_b32 v252, s54
    v_mov_b32 v253, s55
    v_mov_b32_e64 v254, 0
    buffer_store_dwordx2 v[252:253], v254, s[28:31], s80 offen sc1
    s_mov_b32 s80, 0x7ffffff0
    s_mov_b32 exec_lo, 0x3fff
    s_mov_b32 exec_hi, 0x3fff
    s_mov_b32 s74, 0x400000
L_pollg_12:
    buffer_load_dwordx2 v[234:235], v232, s[28:31], s56 offen sc1
    s_sub_u32 s74, s74, 1
    s_cbranch_scc1 L_pollok_11
    s_waitcnt vmcnt(0)
    v_cmp_eq_u64 vcc, s[54:55], v[234:235]
    s_nop 0
    s_or_b32 vcc_lo, vcc_lo, vcc_hi
    s_cmp_lg_u32 vcc_lo, 0x3fff
    s_cbranch_scc1 L_pollg_12
L_pollok_11:
    s_waitcnt vmcnt(0)
    s_mov_b64 exec, -1
    buffer_load_dwordx4 v[16:19], v2, s[28:31], s58 offen offset:0 sc1
    buffer_load_dwordx4 v[20:23], v2, s[28:31], s58 offen offset:1024 sc1
    buffer_load_dwordx4 v[24:27], v2, s[28:31], s58 offen offset:2048 sc1
    buffer_load_dwordx4 v[28:31], v2, s[28:31], s58 offen offset:3072 sc1
    s_add_u32 s58, s58, 4096
    buffer_load_dwordx4 v[32:35], v2, s[28:31], s58 offen offset:0 sc1
    buffer_load_dwordx4 v[36:39], v2, s[28:31], s58 offen offset:1024 sc1
    buffer_load_dwordx4 v[40:43], v2, s[28:31], s58 offen offset:2048 sc1
    buffer_load_dwordx4 v[44:47], v2, s[28:31], s58 offen offset:3072 sc1
    s_add_u32 s58, s58, 4096
    buffer_load_dwordx4 v[48:51], v2, s[28:31], s58 offen offset:0 sc1
    v_add_u32 v237, 57344, v8
    v_add_u32 v238, 57344, v236
    s_mul_i32 s4, s69, 112
    s_lshl_b32 s56, s53, 3
    s_add_u32 s4, s4, s56
    s_lshl_b32 s4, s4, 10
    s_add_u32 s4, s4, 9437184
    s_add_u32 s5, s4, 4096
    s_lshl_b32 s6, s69, 4
    s_add_u32 s6, s6, s53
    s_lshl_b32 s6, s6, 7
    s_add_u32 s6, s6, 393216
    s_waitcnt vmcnt(8) lgkmcnt(4)
    v_mfma_f32_32x32x16_bf16 v[128:143], v[192:195], v[16:19], 0
    ds_read_b64_tr_b16 v[208:209], v8 offset:4096
    ds_read_b64_tr_b16 v[210:211], v8 offset:5120
    ds_read_b64_tr_b16 v[212:213], v236 offset:4096
    ds_read_b64_tr_b16 v[214:215], v236 offset:5120
    v_mfma_f32_32x32x16_bf16 v[144:159], v[196:199], v[16:19], 0
    buffer_load_dwordx4 v[52:55], v2, s[28:31], s58 offen offset:1024 sc1
    buffer_load_dwordx2 v[160:161], v228, s[28:31], s59 offen offset:0 sc1
    s_waitcnt vmcnt(9) lgkmcnt(4)
    v_mfma_f32_32x32x16_bf16 v[128:143], v[200:203], v[20:23], v[128:143]
    ds_read_b64_tr_b16 v[192:193], v8 offset:6144
    ds_read_b64_tr_b16 v[194:195], v8 offset:7168
    ds_read_b64_tr_b16 v[196:197], v236 offset:6144
    ds_read_b64_tr_b16 v[198:199], v236 offset:7168
    v_mfma_f32_32x32x16_bf16 v[144:159], v[204:207], v[20:23], v[144:159]
    buffer_load_dwordx4 v[56:59], v2, s[28:31], s58 offen offset:2048 sc1
    buffer_load_dwordx2 v[162:163], v228, s[28:31], s59 offen offset:512 sc1
    s_waitcnt vmcnt(10) lgkmcnt(4)
    v_mfma_f32_32x32x16_bf16 v[128:143], v[208:211], v[24:27], v[128:143]
    ds_read_b64_tr_b16 v[200:201], v8 offset:8192
    ds_read_b64_tr_b16 v[202:203], v8 offset:9216
    ds_read_b64_tr_b16 v[204:205], v236 offset:8192
    ds_read_b64_tr_b16 v[206:207], v236 offset:9216
    v_mfma_f32_32x32x16_bf16 v[144:159], v[212:215], v[24:27], v[144:159]
    buffer_load_dwordx4 v[60:63], v2, s[28:31], s58 offen offset:3072 sc1
    buffer_load_dwordx2 v[164:165], v228, s[28:31], s59 offen offset:1024 sc1
    s_waitcnt vmcnt(11) lgkmcnt(4)
    v_mfma_f32_32x32x16_bf16 v[128:143], v[192:195], v[28:31], v[128:143]
    ds_read_b64_tr_b16 v[208:209], v8 offset:10240
    ds_read_b64_tr_b16 v[210:211], v8 offset:11264
    ds_read_b64_tr_b16 v[212:213], v236 offset:10240
    ds_read_b64_tr_b16 v[214:215], v236 offset:11264
    v_mfma_f32_32x32x16_bf16 v[144:159], v[196:199], v[28:31], v[144:159]
    s_add_u32 s58, s58, 4096
    buffer_load_dwordx4 v[64:67], v2, s[28:31], s58 offen offset:0 sc1
    buffer_load_dwordx2 v[166:167], v228, s[28:31], s59 offen offset:1536 sc1
    s_waitcnt vmcnt(12) lgkmcnt(4)
    v_mfma_f32_32x32x16_bf16 v[128:143], v[200:203], v[32:35], v[128:143]
    ds_read_b64_tr_b16 v[192:193], v8 offset:12288
    ds_read_b64_tr_b16 v[194:195], v8 offset:13312
    ds_read_b64_tr_b16 v[196:197], v236 offset:12288
    ds_read_b64_tr_b16 v[198:199], v236 offset:13312
    v_mfma_f32_32x32x16_bf16 v[144:159], v[204:207], v[32:35], v[144:159]
    buffer_load_dwordx4 v[68:71], v2, s[28:31], s58 offen offset:1024 sc1
    buffer_load_dwordx2 v[168:169], v228, s[28:31], s59 offen offset:2048 sc1
    s_waitcnt vmcnt(13) lgkmcnt(4)
    v_mfma_f32_32x32x16_bf16 v[128:143], v[208:211], v[36:39], v[128:143]
    ds_read_b64_tr_b16 v[200:201], v8 offset:14336
    ds_read_b64_tr_b16 v[202:203], v8 offset:15360
    ds_read_b64_tr_b16 v[204:205], v236 offset:14336
    ds_read_b64_tr_b16 v[206:207], v236 offset:15360
    v_mfma_f32_32x32x16_bf16 v[144:159], v[212:215], v[36:39], v[144:159]
    buffer_load_dwordx4 v[72:75], v2, s[28:31], s58 offen offset:2048 sc1
    buffer_load_dwordx2 v[170:171], v228, s[28:31], s59 offen offset:2560 sc1
    s_waitcnt vmcnt(14) lgkmcnt(4)
    v_mfma_f32_32x32x16_bf16 v[128:143], v[192:195], v[40:43], v[128:143]
    ds_read_b64_tr_b16 v[208:209], v8 offset:16384
    ds_read_b64_tr_b16 v[210:211], v8 offset:17408
    ds_read_b64_tr_b16 v[212:213], v236 offset:16384
    ds_read_b64_tr_b16 v[214:215], v236 offset:17408
    v_mfma_f32_32x32x16_bf16 v[144:159], v[196:199], v[40:43], v[144:159]
    buffer_load_dwordx4 v[76:79], v2, s[28:31], s58 offen offset:3072 sc1
    buffer_load_dwordx2 v[172:173], v228, s[28:31], s59 offen offset:3072 sc1
    s_waitcnt vmcnt(15) lgkmcnt(4)
    v_mfma_f32_32x32x16_bf16 v[128:143], v[200:203], v[44:47], v[128:143]
    ds_read_b64_tr_b16 v[192:193], v8 offset:18432
    ds_read_b64_tr_b16 v[194:195], v8 offset:19456
    ds_read_b64_tr_b16 v[196:197], v236 offset:18432
    ds_read_b64_tr_b16 v[198:199], v236 offset:19456
    v_mfma_f32_32x32x16_bf16 v[144:159], v[204:207], v[44:47], v[144:159]
    s_add_u32 s58, s58, 4096
    buffer_load_dwordx4 v[80:83], v2, s[28:31], s58 offen offset:0 sc1
    s_waitcnt vmcnt(15) lgkmcnt(4)
    v_mfma_f32_32x32x16_bf16 v[128:143], v[208:211], v[48:51], v[128:143]
    ds_read_b64_tr_b16 v[200:201], v8 offset:20480
    ds_read_b64_tr_b16 v[202:203], v8 offset:21504
    ds_read_b64_tr_b16 v[204:205], v236 offset:20480
    ds_read_b64_tr_b16 v[206:207], v236 offset:21504
    v_mfma_f32_32x32x16_bf16 v[144:159], v[212:215], v[48:51], v[144:159]
    buffer_load_dwordx4 v[84:87], v2, s[28:31], s58 offen offset:1024 sc1
    s_waitcnt vmcnt(15) lgkmcnt(4)
    v_mfma_f32_32x32x16_bf16 v[128:143], v[192:195], v[52:55], v[128:143]
    ds_read_b64_tr_b16 v[208:209], v8 offset:22528
    ds_read_b64_tr_b16 v[210:211], v8 offset:23552
    ds_read_b64_tr_b16 v[212:213], v236 offset:22528
    ds_read_b64_tr_b16 v[214:215], v236 offset:23552
    v_mfma_f32_32x32x16_bf16 v[144:159], v[196:199], v[52:55], v[144:159]
    buffer_load_dwordx4 v[88:91], v2, s[28:31], s58 offen offset:2048 sc1
    s_waitcnt vmcnt(14) lgkmcnt(4)
    v_mfma_f32_32x32x16_bf16 v[128:143], v[200:203], v[56:59], v[128:143]
    ds_read_b64_tr_b16 v[192:193], v8 offset:24576
    ds_read_b64_tr_b16 v[194:195], v8 offset:25600
    ds_read_b64_tr_b16 v[196:197], v236 offset:24576
    ds_read_b64_tr_b16 v[198:199], v236 offset:25600
    v_mfma_f32_32x32x16_bf16 v[144:159], v[204:207], v[56:59], v[144:159]
    buffer_load_dwordx4 v[92:95], v2, s[28:31], s58 offen offset:3072 sc1
    s_waitcnt vmcnt(13) lgkmcnt(4)
    v_mfma_f32_32x32x16_bf16 v[128:143], v[208:211], v[60:63], v[128:143]
    ds_read_b64_tr_b16 v[200:201], v8 offset:26624
    ds_read_b64_tr_b16 v[202:203], v8 offset:27648
    ds_read_b64_tr_b16 v[204:205], v236 offset:26624
    ds_read_b64_tr_b16 v[206:207], v236 offset:27648
    v_mfma_f32_32x32x16_bf16 v[144:159], v[212:215], v[60:63], v[144:159]
    s_add_u32 s58, s58, 4096
    buffer_load_dwordx4 v[96:99], v2, s[28:31], s58 offen offset:0 sc1
    s_waitcnt vmcnt(12) lgkmcnt(4)
    v_mfma_f32_32x32x16_bf16 v[128:143], v[192:195], v[64:67], v[128:143]
    ds_read_b64_tr_b16 v[208:209], v8 offset:28672
    ds_read_b64_tr_b16 v[210:211], v8 offset:29696
    ds_read_b64_tr_b16 v[212:213], v236 offset:28672
    ds_read_b64_tr_b16 v[214:215], v236 offset:29696
    v_mfma_f32_32x32x16_bf16 v[144:159], v[196:199], v[64:67], v[144:159]
    buffer_load_dwordx4 v[100:103], v2, s[28:31], s58 offen offset:1024 sc1
    s_waitcnt vmcnt(11) lgkmcnt(4)
    v_mfma_f32_32x32x16_bf16 v[128:143], v[200:203], v[68:71], v[128:143]
    ds_read_b64_tr_b16 v[192:193], v8 offset:30720
    ds_read_b64_tr_b16 v[194:195], v8 offset:31744
    ds_read_b64_tr_b16 v[196:197], v236 offset:30720
    ds_read_b64_tr_b16 v[198:199], v236 offset:31744
    v_mfma_f32_32x32x16_bf16 v[144:159], v[204:207], v[68:71], v[144:159]
    buffer_load_dwordx4 v[104:107], v2, s[28:31], s58 offen offset:2048 sc1
    s_waitcnt vmcnt(10) lgkmcnt(4)
    v_mfma_f32_32x32x16_bf16 v[128:143], v[208:211], v[72:75], v[128:143]
    ds_read_b64_tr_b16 v[200:201], v8 offset:32768
    ds_read_b64_tr_b16 v[202:203], v8 offset:33792
    ds_read_b64_tr_b16 v[204:205], v236 offset:32768
    ds_read_b64_tr_b16 v[206:207], v236 offset:33792
    v_mfma_f32_32x32x16_bf16 v[144:159], v[212:215], v[72:75], v[144:159]
    buffer_load_dwordx4 v[108:111], v2, s[28:31], s58 offen offset:3072 sc1
    s_waitcnt vmcnt(9) lgkmcnt(4)
    v_mfma_f32_32x32x16_bf16 v[128:143], v[192:195], v[76:79], v[128:143]
    ds_read_b64_tr_b16 v[208:209], v8 offset:34816
    ds_read_b64_tr_b16 v[210:211], v8 offset:35840
    ds_read_b64_tr_b16 v[212:213], v236 offset:34816
    ds_read_b64_tr_b16 v[214:215], v236 offset:35840
    v_mfma_f32_32x32x16_bf16 v[144:159], v[196:199], v[76:79], v[144:159]
    s_add_u32 s58, s58, 4096
    buffer_load_dwordx4 v[112:115], v2, s[28:31], s58 offen offset:0 sc1
    s_waitcnt vmcnt(8) lgkmcnt(4)
    v_mfma_f32_32x32x16_bf16 v[128:143], v[200:203], v[80:83], v[128:143]
    ds_read_b64_tr_b16 v[192:193], v8 offset:36864
    ds_read_b64_tr_b16 v[194:195], v8 offset:37888
    ds_read_b64_tr_b16 v[196:197], v236 offset:36864
    ds_read_b64_tr_b16 v[198:199], v236 offset:37888
    v_mfma_f32_32x32x16_bf16 v[144:159], v[204:207], v[80:83], v[144:159]
    buffer_load_dwordx4 v[116:119], v2, s[28:31], s58 offen offset:1024 sc1
    v_add_f32 v160, v160, v162
    s_waitcnt vmcnt(8) lgkmcnt(4)
    v_mfma_f32_32x32x16_bf16 v[128:143], v[208:211], v[84:87], v[128:143]
    ds_read_b64_tr_b16 v[200:201], v8 offset:38912
    ds_read_b64_tr_b16 v[202:203], v8 offset:39936
    ds_read_b64_tr_b16 v[204:205], v236 offset:38912
    ds_read_b64_tr_b16 v[206:207], v236 offset:39936
    v_mfma_f32_32x32x16_bf16 v[144:159], v[212:215], v[84:87], v[144:159]
    buffer_load_dwordx4 v[120:123], v2, s[28:31], s58 offen offset:2048 sc1
    v_add_f32 v161, v161, v163
    v_add_f32_e64 v160, v160, v164
    s_waitcnt vmcnt(8) lgkmcnt(4)
    v_mfma_f32_32x32x16_bf16 v[128:143], v[192:195], v[88:91], v[128:143]
    ds_read_b64_tr_b16 v[208:209], v8 offset:40960
    ds_read_b64_tr_b16 v[210:211], v8 offset:41984
    ds_read_b64_tr_b16 v[212:213], v236 offset:40960
    ds_read_b64_tr_b16 v[214:215], v236 offset:41984
    v_mfma_f32_32x32x16_bf16 v[144:159], v[196:199], v[88:91], v[144:159]
    buffer_load_dwordx4 v[124:127], v2, s[28:31], s58 offen offset:3072 sc1
    v_add_f32 v161, v161, v165
    v_add_f32_e64 v160, v160, v166
    s_waitcnt vmcnt(8) lgkmcnt(4)
    v_mfma_f32_32x32x16_bf16 v[128:143], v[200:203], v[92:95], v[128:143]
    ds_read_b64_tr_b16 v[192:193], v8 offset:43008
    ds_read_b64_tr_b16 v[194:195], v8 offset:44032
    ds_read_b64_tr_b16 v[196:197], v236 offset:43008
    ds_read_b64_tr_b16 v[198:199], v236 offset:44032
    v_mfma_f32_32x32x16_bf16 v[144:159], v[204:207], v[92:95], v[144:159]
    v_add_f32 v161, v161, v167
    v_add_f32 v160, v160, v168
    v_add_f32 v161, v161, v169
    v_add_f32 v160, v160, v170
    v_add_f32 v161, v161, v171
    v_add_f32_e64 v160, v160, v172
    s_waitcnt vmcnt(7) lgkmcnt(4)
    v_mfma_f32_32x32x16_bf16 v[128:143], v[208:211], v[96:99], v[128:143]
    ds_read_b64_tr_b16 v[200:201], v8 offset:45056
    ds_read_b64_tr_b16 v[202:203], v8 offset:46080
    ds_read_b64_tr_b16 v[204:205], v236 offset:45056
    ds_read_b64_tr_b16 v[206:207], v236 offset:46080
    v_mfma_f32_32x32x16_bf16 v[144:159], v[212:215], v[96:99], v[144:159]
    v_add_f32 v161, v161, v173
    v_mov_b32 v162, v160
    v_mov_b32_e64 v163, v161
    v_mov_b32 v230, 0xc09d30fc
    v_mov_b32 v232, 0x3eeff558
    v_permlane32_swap_b32 v160, v162
    s_waitcnt vmcnt(6) lgkmcnt(4)
    v_mfma_f32_32x32x16_bf16 v[128:143], v[192:195], v[100:103], v[128:143]
    ds_read_b64_tr_b16 v[208:209], v8 offset:47104
    ds_read_b64_tr_b16 v[210:211], v8 offset:48128
    ds_read_b64_tr_b16 v[212:213], v236 offset:47104
    ds_read_b64_tr_b16 v[214:215], v236 offset:48128
    v_mfma_f32_32x32x16_bf16 v[144:159], v[196:199], v[100:103], v[144:159]
    v_permlane32_swap_b32 v161, v163
    v_add_f32 v160, v160, v162
    v_add_f32_e64 v161, v161, v163
    v_mul_f32 v160, 0xbb124925, v160
    v_mul_f32 v161, 0x3b124925, v161
    v_fma_f32 v161, -v160, v160, v161
    s_waitcnt vmcnt(5) lgkmcnt(4)
    v_mfma_f32_32x32x16_bf16 v[128:143], v[200:203], v[104:107], v[128:143]
    ds_read_b64_tr_b16 v[192:193], v8 offset:49152
    ds_read_b64_tr_b16 v[194:195], v8 offset:50176
    ds_read_b64_tr_b16 v[196:197], v236 offset:49152
    ds_read_b64_tr_b16 v[198:199], v236 offset:50176
    v_mfma_f32_32x32x16_bf16 v[144:159], v[204:207], v[104:107], v[144:159]
    v_max_f32 v161, 0, v161
    v_add_f32 v162, 0x3727c5ac, v161
    v_rsq_f32_e64 v163, v162
    v_cvt_pk_bf16_f32 v224, v160, v160
    v_mul_f32 v162, v163, v163
    v_mul_f32_e64 v162, v162, v161
    s_waitcnt vmcnt(4) lgkmcnt(4)
    v_mfma_f32_32x32x16_bf16 v[128:143], v[208:211], v[108:111], v[128:143]
    ds_read_b64_tr_b16 v[200:201], v8 offset:51200
    ds_read_b64_tr_b16 v[202:203], v8 offset:52224
    ds_read_b64_tr_b16 v[204:205], v236 offset:51200
    ds_read_b64_tr_b16 v[206:207], v236 offset:52224
    v_mfma_f32_32x32x16_bf16 v[144:159], v[212:215], v[108:111], v[144:159]
    v_add_f32 v162, 0x3727c5ac, v162
    v_rsq_f32 v162, v162
    v_lshlrev_b32 v164, 16, v224
    v_sub_f32 v164, v160, v164
    v_mul_f32 v162, v162, v163
    v_cvt_pk_bf16_f32 v225, v164, v164
    s_waitcnt vmcnt(3) lgkmcnt(4)
    v_mfma_f32_32x32x16_bf16 v[128:143], v[192:195], v[112:115], v[128:143]
    ds_read_b64_tr_b16 v[208:209], v8 offset:53248
    ds_read_b64_tr_b16 v[210:211], v8 offset:54272
    ds_read_b64_tr_b16 v[212:213], v236 offset:53248
    ds_read_b64_tr_b16 v[214:215], v236 offset:54272
    v_mfma_f32_32x32x16_bf16 v[144:159], v[196:199], v[112:115], v[144:159]
    v_rcp_f32_e64 v163, v162
    s_nop 0
    v_mul_f32 v228, 0x3eeff558, v162
    v_cvt_pk_bf16_f32 v164, v163, v163
    v_lshlrev_b32 v164, 16, v164
    v_sub_f32_e64 v164, v163, v164
    s_waitcnt vmcnt(2) lgkmcnt(4)
    v_mfma_f32_32x32x16_bf16 v[128:143], v[200:203], v[116:119], v[128:143]
    ds_read_b64_tr_b16 v[192:193], v8 offset:55296
    ds_read_b64_tr_b16 v[194:195], v8 offset:56320
    ds_read_b64_tr_b16 v[196:197], v236 offset:55296
    ds_read_b64_tr_b16 v[198:199], v236 offset:56320
    v_mfma_f32_32x32x16_bf16 v[144:159], v[204:207], v[116:119], v[144:159]
    v_cvt_pk_bf16_f32 v226, v163, v164
    v_mov_b32_e64 v227, 0
    v_cndmask_b32 v224, v224, v227, s[60:61]
    v_cndmask_b32 v225, v225, v227, s[60:61]
    v_cndmask_b32 v226, v226, v227, s[60:61]
    s_mov_b64 exec, 1
    v_mov_b32 v252, s54
    v_mov_b32 v253, s55
    v_mov_b32 v254, 0
    buffer_store_dwordx2 v[252:253], v254, s[28:31], s80 offen sc1
    s_mov_b32 s80, 0x7ffffff0
    s_mov_b64 exec, -1
    s_waitcnt vmcnt(2) lgkmcnt(4)
    v_mfma_f32_32x32x16_bf16 v[128:143], v[208:211], v[120:123], v[128:143]
    v_mfma_f32_32x32x16_bf16 v[144:159], v[212:215], v[120:123], v[144:159]
    v_mov_b32 v216, v188
    v_mov_b32 v217, v189
    v_mov_b32 v218, v190
    v_mov_b32 v219, v191
    v_mov_b32 v252, s54
    v_mov_b32_e64 v253, s55
    s_waitcnt vmcnt(1) lgkmcnt(0)
    v_mfma_f32_32x32x16_bf16 v[128:143], v[192:195], v[124:127], v[128:143]
    v_mfma_f32_32x32x16_bf16 v[144:159], v[196:199], v[124:127], v[144:159]
    v_mov_b32_e64 v254, 0
    v_mov_b32 v255, 0x1000000
    v_mfma_f32_32x32x16_bf16 v[128:143], v[176:179], v[224:227], v[128:143]
    ds_read_b64_tr_b16 v[192:193], v237 offset:0
    ds_read_b64_tr_b16 v[194:195], v237 offset:1024
    v_mfma_f32_32x32x16_bf16 v[144:159], v[180:183], v[224:227], v[144:159]
    ds_read_b64_tr_b16 v[196:197], v237 offset:2048
    ds_read_b64_tr_b16 v[198:199], v237 offset:3072
    v_mfma_f32_32x32x16_bf16 v[160:175], v[184:187], v[224:227], 0
    ds_read_b64_tr_b16 v[200:201], v237 offset:4096
    ds_read_b64_tr_b16 v[202:203], v237 offset:5120
    v_mfma_f32_32x32x16_bf16 v[176:191], v[216:219], v[224:227], 0
    s_waitcnt lgkmcnt(2)
    v_mfma_f32_32x32x16_bf16 v[160:175], v[192:195], v[16:19], v[160:175]
    ds_read_b64_tr_b16 v[204:205], v237 offset:6144
    ds_read_b64_tr_b16 v[206:207], v237 offset:7168
    v_mfma_f32_32x32x16_bf16 v[160:175], v[196:199], v[20:23], v[160:175]
    ds_read_b64_tr_b16 v[192:193], v237 offset:8192
    ds_read_b64_tr_b16 v[194:195], v237 offset:9216
    v_mul_f32 v128, v128, v228
    v_mul_f32 v129, v129, v228
    v_mul_f32 v130, v130, v228
    v_mul_f32 v131, v131, v228
    v_mul_f32 v132, v132, v228
    v_mul_f32 v133, v133, v228
    v_mul_f32_e64 v134, v134, v228
    s_waitcnt lgkmcnt(2)
    v_mfma_f32_32x32x16_bf16 v[160:175], v[200:203], v[24:27], v[160:175]
    ds_read_b64_tr_b16 v[196:197], v237 offset:10240
    ds_read_b64_tr_b16 v[198:199], v237 offset:11264
    v_mul_f32_e64 v135, v135, v228
    v_fma_f32 v208, -v128, v128, v230
    v_fma_f32 v209, -v129, v129, v230
    v_fma_f32 v210, -v130, v130, v230
    v_fma_f32 v211, -v131, v131, v230
    v_fma_f32 v212, -v132, v132, v230
    v_fma_f32 v213, -v133, v133, v230
    v_mfma_f32_32x32x16_bf16 v[160:175], v[204:207], v[28:31], v[160:175]
    ds_read_b64_tr_b16 v[200:201], v237 offset:12288
    ds_read_b64_tr_b16 v[202:203], v237 offset:13312
    v_fma_f32 v214, -v134, v134, v230
    v_fma_f32 v215, -v135, v135, v230
    v_mul_f32 v208, v208, v128
    v_mul_f32 v209, v209, v129
    v_mul_f32 v210, v210, v130
    v_mul_f32 v211, v211, v131
    v_mul_f32 v212, v212, v132
    s_waitcnt lgkmcnt(2)
    v_mfma_f32_32x32x16_bf16 v[160:175], v[192:195], v[32:35], v[160:175]
    ds_read_b64_tr_b16 v[204:205], v237 offset:14336
    ds_read_b64_tr_b16 v[206:207], v237 offset:15360
    v_mul_f32 v213, v213, v133
    v_mul_f32 v214, v214, v134
    v_mul_f32 v215, v215, v135
    v_exp_f32 v208, v208
    v_exp_f32_e64 v209, v209
    v_mfma_f32_32x32x16_bf16 v[160:175], v[196:199], v[36:39], v[160:175]
    ds_read_b64_tr_b16 v[192:193], v237 offset:16384
    ds_read_b64_tr_b16 v[194:195], v237 offset:17408
    v_exp_f32 v210, v210
    v_exp_f32 v211, v211
    v_exp_f32 v212, v212
    v_exp_f32_e64 v213, v213
    s_waitcnt lgkmcnt(2)
    v_mfma_f32_32x32x16_bf16 v[160:175], v[200:203], v[40:43], v[160:175]
    ds_read_b64_tr_b16 v[196:197], v237 offset:18432
    ds_read_b64_tr_b16 v[198:199], v237 offset:19456
    v_exp_f32 v214, v214
    v_exp_f32 v215, v215
    v_fma_f32 v208, v208, v232, v232
    v_fma_f32 v209, v209, v232, v232
    v_mfma_f32_32x32x16_bf16 v[160:175], v[204:207], v[44:47], v[160:175]
    ds_read_b64_tr_b16 v[200:201], v237 offset:20480
    ds_read_b64_tr_b16 v[202:203], v237 offset:21504
    v_fma_f32 v210, v210, v232, v232
    v_fma_f32 v211, v211, v232, v232
    v_fma_f32 v212, v212, v232, v232
    v_fma_f32 v213, v213, v232, v232
    v_fma_f32 v214, v214, v232, v232
    v_fma_f32 v215, v215, v232, v232
    v_rcp_f32 v208, v208
    s_waitcnt lgkmcnt(2)
    v_mfma_f32_32x32x16_bf16 v[160:175], v[192:195], v[48:51], v[160:175]
    ds_read_b64_tr_b16 v[204:205], v237 offset:22528
    ds_read_b64_tr_b16 v[206:207], v237 offset:23552
    v_rcp_f32 v209, v209
    v_rcp_f32 v210, v210
    v_rcp_f32_e64 v211, v211
    v_mfma_f32_32x32x16_bf16 v[160:175], v[196:199], v[52:55], v[160:175]
    ds_read_b64_tr_b16 v[192:193], v237 offset:24576
    ds_read_b64_tr_b16 v[194:195], v237 offset:25600
    v_rcp_f32 v212, v212
    v_rcp_f32 v213, v213
    v_rcp_f32 v214, v214
    v_rcp_f32_e64 v215, v215
    s_waitcnt lgkmcnt(2)
    v_mfma_f32_32x32x16_bf16 v[160:175], v[200:203], v[56:59], v[160:175]
    ds_read_b64_tr_b16 v[196:197], v237 offset:26624
    ds_read_b64_tr_b16 v[198:199], v237 offset:27648
    v_mul_f32 v128, v128, v208
    v_mul_f32 v129, v129, v209
    v_mul_f32 v130, v130, v210
    v_mul_f32 v131, v131, v211
    v_mul_f32 v132, v132, v212
    v_mul_f32 v133, v133, v213
    v_mfma_f32_32x32x16_bf16 v[160:175], v[204:207], v[60:63], v[160:175]
    ds_read_b64_tr_b16 v[200:201], v237 offset:28672
    ds_read_b64_tr_b16 v[202:203], v237 offset:29696
    v_mul_f32 v134, v134, v214
    v_mul_f32 v135, v135, v215
    v_cvt_pk_bf16_f32 v128, v128, v129
    v_cvt_pk_bf16_f32 v129, v130, v131
    v_cvt_pk_bf16_f32 v130, v132, v133
    v_cvt_pk_bf16_f32 v131, v134, v135
    buffer_store_dwordx4 v[128:131], v2, s[28:31], s4 offen offset:0 sc1
    s_waitcnt lgkmcnt(2)
    v_mfma_f32_32x32x16_bf16 v[160:175], v[192:195], v[64:67], v[160:175]
    ds_read_b64_tr_b16 v[204:205], v237 offset:30720
    ds_read_b64_tr_b16 v[206:207], v237 offset:31744
    v_mul_f32 v136, v136, v228
    v_mul_f32 v137, v137, v228
    v_mul_f32 v138, v138, v228
    v_mul_f32 v139, v139, v228
    v_mul_f32 v140, v140, v228
    v_mul_f32 v141, v141, v228
    v_mul_f32 v142, v142, v228
    v_mfma_f32_32x32x16_bf16 v[160:175], v[196:199], v[68:71], v[160:175]
    ds_read_b64_tr_b16 v[192:193], v237 offset:32768
    ds_read_b64_tr_b16 v[194:195], v237 offset:33792
    v_mul_f32_e64 v143, v143, v228
    v_fma_f32 v216, -v136, v136, v230
    v_fma_f32 v217, -v137, v137, v230
    v_fma_f32 v218, -v138, v138, v230
    v_fma_f32 v219, -v139, v139, v230
    v_fma_f32 v220, -v140, v140, v230
    v_fma_f32 v221, -v141, v141, v230
    s_waitcnt lgkmcnt(2)
    v_mfma_f32_32x32x16_bf16 v[160:175], v[200:203], v[72:75], v[160:175]
    ds_read_b64_tr_b16 v[196:197], v237 offset:34816
    ds_read_b64_tr_b16 v[198:199], v237 offset:35840
    v_fma_f32 v222, -v142, v142, v230
    v_fma_f32 v223, -v143, v143, v230
    v_mul_f32 v216, v216, v136
    v_mul_f32 v217, v217, v137
    v_mul_f32 v218, v218, v138
    v_mul_f32 v219, v219, v139
    v_mul_f32 v220, v220, v140
    v_mfma_f32_32x32x16_bf16 v[160:175], v[204:207], v[76:79], v[160:175]
    ds_read_b64_tr_b16 v[200:201], v237 offset:36864
    ds_read_b64_tr_b16 v[202:203], v237 offset:37888
    v_mul_f32 v221, v221, v141
    v_mul_f32 v222, v222, v142
    v_mul_f32 v223, v223, v143
    v_exp_f32 v216, v216
    v_exp_f32 v217, v217
    s_waitcnt lgkmcnt(2)
    v_mfma_f32_32x32x16_bf16 v[160:175], v[192:195], v[80:83], v[160:175]
    ds_read_b64_tr_b16 v[204:205], v237 offset:38912
    ds_read_b64_tr_b16 v[206:207], v237 offset:39936
    v_exp_f32 v218, v218
    v_exp_f32 v219, v219
    v_exp_f32 v220, v220
    v_exp_f32 v221, v221
    v_mfma_f32_32x32x16_bf16 v[160:175], v[196:199], v[84:87], v[160:175]
    ds_read_b64_tr_b16 v[192:193], v237 offset:40960
    ds_read_b64_tr_b16 v[194:195], v237 offset:41984
    v_exp_f32 v222, v222
    v_exp_f32 v223, v223
    v_fma_f32 v216, v216, v232, v232
    v_fma_f32 v217, v217, v232, v232
    s_waitcnt lgkmcnt(2)
    v_mfma_f32_32x32x16_bf16 v[160:175], v[200:203], v[88:91], v[160:175]
    ds_read_b64_tr_b16 v[196:197], v237 offset:43008
    ds_read_b64_tr_b16 v[198:199], v237 offset:44032
    v_fma_f32 v218, v218, v232, v232
    v_fma_f32 v219, v219, v232, v232
    v_fma_f32 v220, v220, v232, v232
    v_fma_f32 v221, v221, v232, v232
    v_fma_f32 v222, v222, v232, v232
    v_fma_f32 v223, v223, v232, v232
    v_rcp_f32 v216, v216
    v_mfma_f32_32x32x16_bf16 v[160:175], v[204:207], v[92:95], v[160:175]
    ds_read_b64_tr_b16 v[200:201], v237 offset:45056
    ds_read_b64_tr_b16 v[202:203], v237 offset:46080
    v_rcp_f32 v217, v217
    v_rcp_f32 v218, v218
    v_rcp_f32 v219, v219
    s_waitcnt lgkmcnt(2)
    v_mfma_f32_32x32x16_bf16 v[160:175], v[192:195], v[96:99], v[160:175]
    ds_read_b64_tr_b16 v[204:205], v237 offset:47104
    ds_read_b64_tr_b16 v[206:207], v237 offset:48128
    v_rcp_f32 v220, v220
    v_rcp_f32 v221, v221
    v_rcp_f32 v222, v222
    v_rcp_f32 v223, v223
    v_mfma_f32_32x32x16_bf16 v[160:175], v[196:199], v[100:103], v[160:175]
    ds_read_b64_tr_b16 v[192:193], v237 offset:49152
    ds_read_b64_tr_b16 v[194:195], v237 offset:50176
    v_mul_f32 v136, v136, v216
    v_mul_f32 v137, v137, v217
    v_mul_f32 v138, v138, v218
    v_mul_f32 v139, v139, v219
    v_mul_f32 v140, v140, v220
    v_mul_f32_e64 v141, v141, v221
    s_waitcnt lgkmcnt(2)
    v_mfma_f32_32x32x16_bf16 v[160:175], v[200:203], v[104:107], v[160:175]
    ds_read_b64_tr_b16 v[196:197], v237 offset:51200
    ds_read_b64_tr_b16 v[198:199], v237 offset:52224
    v_mul_f32 v142, v142, v222
    v_mul_f32 v143, v143, v223
    v_cvt_pk_bf16_f32 v132, v136, v137
    v_cvt_pk_bf16_f32 v133, v138, v139
    v_cvt_pk_bf16_f32 v134, v140, v141
    v_cvt_pk_bf16_f32 v135, v142, v143
    buffer_store_dwordx4 v[132:135], v2, s[28:31], s4 offen offset:1024 sc1
    v_mfma_f32_32x32x16_bf16 v[160:175], v[204:207], v[108:111], v[160:175]
    ds_read_b64_tr_b16 v[200:201], v237 offset:53248
    ds_read_b64_tr_b16 v[202:203], v237 offset:54272
    v_mul_f32 v144, v144, v228
    v_mul_f32 v145, v145, v228
    v_mul_f32 v146, v146, v228
    v_mul_f32 v147, v147, v228
    v_mul_f32 v148, v148, v228
    v_mul_f32 v149, v149, v228
    v_mul_f32 v150, v150, v228
    s_waitcnt lgkmcnt(2)
    v_mfma_f32_32x32x16_bf16 v[160:175], v[192:195], v[112:115], v[160:175]
    ds_read_b64_tr_b16 v[204:205], v237 offset:55296
    ds_read_b64_tr_b16 v[206:207], v237 offset:56320
    v_mul_f32_e64 v151, v151, v228
    v_fma_f32 v208, -v144, v144, v230
    v_fma_f32 v209, -v145, v145, v230
    v_fma_f32 v210, -v146, v146, v230
    v_fma_f32 v211, -v147, v147, v230
    v_fma_f32 v212, -v148, v148, v230
    v_fma_f32 v213, -v149, v149, v230
    v_mfma_f32_32x32x16_bf16 v[160:175], v[196:199], v[116:119], v[160:175]
    ds_read_b64_tr_b16 v[192:193], v238 offset:0
    ds_read_b64_tr_b16 v[194:195], v238 offset:1024
    v_fma_f32 v214, -v150, v150, v230
    v_fma_f32 v215, -v151, v151, v230
    v_mul_f32 v208, v208, v144
    v_mul_f32 v209, v209, v145
    v_mul_f32 v210, v210, v146
    v_mul_f32 v211, v211, v147
    v_mul_f32 v212, v212, v148
    s_waitcnt lgkmcnt(2)
    v_mfma_f32_32x32x16_bf16 v[160:175], v[200:203], v[120:123], v[160:175]
    ds_read_b64_tr_b16 v[196:197], v238 offset:2048
    ds_read_b64_tr_b16 v[198:199], v238 offset:3072
    v_mul_f32 v213, v213, v149
    v_mul_f32 v214, v214, v150
    v_mul_f32 v215, v215, v151
    v_exp_f32 v208, v208
    v_exp_f32_e64 v209, v209
    v_mfma_f32_32x32x16_bf16 v[160:175], v[204:207], v[124:127], v[160:175]
    ds_read_b64_tr_b16 v[200:201], v238 offset:4096
    ds_read_b64_tr_b16 v[202:203], v238 offset:5120
    v_exp_f32 v210, v210
    v_exp_f32 v211, v211
    v_exp_f32 v212, v212
    v_exp_f32_e64 v213, v213
    s_waitcnt lgkmcnt(2)
    v_mfma_f32_32x32x16_bf16 v[176:191], v[192:195], v[16:19], v[176:191]
    ds_read_b64_tr_b16 v[204:205], v238 offset:6144
    ds_read_b64_tr_b16 v[206:207], v238 offset:7168
    v_exp_f32 v214, v214
    v_exp_f32 v215, v215
    v_fma_f32 v208, v208, v232, v232
    v_fma_f32 v209, v209, v232, v232
    v_mfma_f32_32x32x16_bf16 v[176:191], v[196:199], v[20:23], v[176:191]
    ds_read_b64_tr_b16 v[192:193], v238 offset:8192
    ds_read_b64_tr_b16 v[194:195], v238 offset:9216
    v_fma_f32 v210, v210, v232, v232
    v_fma_f32 v211, v211, v232, v232
    v_fma_f32 v212, v212, v232, v232
    v_fma_f32 v213, v213, v232, v232
    v_fma_f32 v214, v214, v232, v232
    v_fma_f32 v215, v215, v232, v232
    v_rcp_f32 v208, v208
    s_waitcnt lgkmcnt(2)
    v_mfma_f32_32x32x16_bf16 v[176:191], v[200:203], v[24:27], v[176:191]
    ds_read_b64_tr_b16 v[196:197], v238 offset:10240
    ds_read_b64_tr_b16 v[198:199], v238 offset:11264
    v_rcp_f32 v209, v209
    v_rcp_f32 v210, v210
    v_rcp_f32_e64 v211, v211
    v_mfma_f32_32x32x16_bf16 v[176:191], v[204:207], v[28:31], v[176:191]
    ds_read_b64_tr_b16 v[200:201], v238 offset:12288
    ds_read_b64_tr_b16 v[202:203], v238 offset:13312
    v_rcp_f32 v212, v212
    v_rcp_f32 v213, v213
    v_rcp_f32 v214, v214
    v_rcp_f32_e64 v215, v215
    s_waitcnt lgkmcnt(2)
    v_mfma_f32_32x32x16_bf16 v[176:191], v[192:195], v[32:35], v[176:191]
    ds_read_b64_tr_b16 v[204:205], v238 offset:14336
    ds_read_b64_tr_b16 v[206:207], v238 offset:15360
    v_mul_f32 v144, v144, v208
    v_mul_f32 v145, v145, v209
    v_mul_f32 v146, v146, v210
    v_mul_f32 v147, v147, v211
    v_mul_f32 v148, v148, v212
    v_mul_f32 v149, v149, v213
    v_mfma_f32_32x32x16_bf16 v[176:191], v[196:199], v[36:39], v[176:191]
    ds_read_b64_tr_b16 v[192:193], v238 offset:16384
    ds_read_b64_tr_b16 v[194:195], v238 offset:17408
    v_mul_f32 v150, v150, v214
    v_mul_f32 v151, v151, v215
    v_cvt_pk_bf16_f32 v144, v144, v145
    v_cvt_pk_bf16_f32 v145, v146, v147
    v_cvt_pk_bf16_f32 v146, v148, v149
    v_cvt_pk_bf16_f32 v147, v150, v151
    buffer_store_dwordx4 v[144:147], v2, s[28:31], s4 offen offset:2048 sc1
    s_waitcnt lgkmcnt(2)
    v_mfma_f32_32x32x16_bf16 v[176:191], v[200:203], v[40:43], v[176:191]
    ds_read_b64_tr_b16 v[196:197], v238 offset:18432
    ds_read_b64_tr_b16 v[198:199], v238 offset:19456
    v_mul_f32 v152, v152, v228
    v_mul_f32 v153, v153, v228
    v_mul_f32 v154, v154, v228
    v_mul_f32 v155, v155, v228
    v_mul_f32 v156, v156, v228
    v_mul_f32 v157, v157, v228
    v_mul_f32 v158, v158, v228
    v_mfma_f32_32x32x16_bf16 v[176:191], v[204:207], v[44:47], v[176:191]
    ds_read_b64_tr_b16 v[200:201], v238 offset:20480
    ds_read_b64_tr_b16 v[202:203], v238 offset:21504
    v_mul_f32_e64 v159, v159, v228
    v_fma_f32 v216, -v152, v152, v230
    v_fma_f32 v217, -v153, v153, v230
    v_fma_f32 v218, -v154, v154, v230
    v_fma_f32 v219, -v155, v155, v230
    v_fma_f32 v220, -v156, v156, v230
    v_fma_f32 v221, -v157, v157, v230
    s_waitcnt lgkmcnt(2)
    v_mfma_f32_32x32x16_bf16 v[176:191], v[192:195], v[48:51], v[176:191]
    ds_read_b64_tr_b16 v[204:205], v238 offset:22528
    ds_read_b64_tr_b16 v[206:207], v238 offset:23552
    v_fma_f32 v222, -v158, v158, v230
    v_fma_f32 v223, -v159, v159, v230
    v_mul_f32 v216, v216, v152
    v_mul_f32 v217, v217, v153
    v_mul_f32 v218, v218, v154
    v_mul_f32 v219, v219, v155
    v_mul_f32 v220, v220, v156
    v_mfma_f32_32x32x16_bf16 v[176:191], v[196:199], v[52:55], v[176:191]
    ds_read_b64_tr_b16 v[192:193], v238 offset:24576
    ds_read_b64_tr_b16 v[194:195], v238 offset:25600
    v_mul_f32 v221, v221, v157
    v_mul_f32 v222, v222, v158
    v_mul_f32 v223, v223, v159
    v_exp_f32 v216, v216
    v_exp_f32 v217, v217
    s_waitcnt lgkmcnt(2)
    v_mfma_f32_32x32x16_bf16 v[176:191], v[200:203], v[56:59], v[176:191]
    ds_read_b64_tr_b16 v[196:197], v238 offset:26624
    ds_read_b64_tr_b16 v[198:199], v238 offset:27648
    v_exp_f32 v218, v218
    v_exp_f32 v219, v219
    v_exp_f32 v220, v220
    v_exp_f32 v221, v221
    v_mfma_f32_32x32x16_bf16 v[176:191], v[204:207], v[60:63], v[176:191]
    ds_read_b64_tr_b16 v[200:201], v238 offset:28672
    ds_read_b64_tr_b16 v[202:203], v238 offset:29696
    v_exp_f32 v222, v222
    v_exp_f32 v223, v223
    v_fma_f32 v216, v216, v232, v232
    v_fma_f32 v217, v217, v232, v232
    s_waitcnt lgkmcnt(2)
    v_mfma_f32_32x32x16_bf16 v[176:191], v[192:195], v[64:67], v[176:191]
    ds_read_b64_tr_b16 v[204:205], v238 offset:30720
    ds_read_b64_tr_b16 v[206:207], v238 offset:31744
    v_fma_f32 v218, v218, v232, v232
    v_fma_f32 v219, v219, v232, v232
    v_fma_f32 v220, v220, v232, v232
    v_fma_f32 v221, v221, v232, v232
    v_fma_f32 v222, v222, v232, v232
    v_fma_f32 v223, v223, v232, v232
    v_rcp_f32 v216, v216
    v_mfma_f32_32x32x16_bf16 v[176:191], v[196:199], v[68:71], v[176:191]
    ds_read_b64_tr_b16 v[192:193], v238 offset:32768
    ds_read_b64_tr_b16 v[194:195], v238 offset:33792
    v_rcp_f32 v217, v217
    v_rcp_f32 v218, v218
    v_rcp_f32 v219, v219
    s_waitcnt lgkmcnt(2)
    v_mfma_f32_32x32x16_bf16 v[176:191], v[200:203], v[72:75], v[176:191]
    ds_read_b64_tr_b16 v[196:197], v238 offset:34816
    ds_read_b64_tr_b16 v[198:199], v238 offset:35840
    v_rcp_f32 v220, v220
    v_rcp_f32 v221, v221
    v_rcp_f32 v222, v222
    v_rcp_f32 v223, v223
    v_mfma_f32_32x32x16_bf16 v[176:191], v[204:207], v[76:79], v[176:191]
    ds_read_b64_tr_b16 v[200:201], v238 offset:36864
    ds_read_b64_tr_b16 v[202:203], v238 offset:37888
    v_mul_f32 v152, v152, v216
    v_mul_f32 v153, v153, v217
    v_mul_f32 v154, v154, v218
    v_mul_f32 v155, v155, v219
    v_mul_f32 v156, v156, v220
    v_mul_f32_e64 v157, v157, v221
    s_waitcnt lgkmcnt(2)
    v_mfma_f32_32x32x16_bf16 v[176:191], v[192:195], v[80:83], v[176:191]
    ds_read_b64_tr_b16 v[204:205], v238 offset:38912
    ds_read_b64_tr_b16 v[206:207], v238 offset:39936
    v_mul_f32 v158, v158, v222
    v_mul_f32 v159, v159, v223
    v_cvt_pk_bf16_f32 v148, v152, v153
    v_cvt_pk_bf16_f32 v149, v154, v155
    v_cvt_pk_bf16_f32 v150, v156, v157
    v_cvt_pk_bf16_f32 v151, v158, v159
    buffer_store_dwordx4 v[148:151], v2, s[28:31], s4 offen offset:3072 sc1
    v_mfma_f32_32x32x16_bf16 v[176:191], v[196:199], v[84:87], v[176:191]
    ds_read_b64_tr_b16 v[192:193], v238 offset:40960
    ds_read_b64_tr_b16 v[194:195], v238 offset:41984
    s_waitcnt lgkmcnt(2)
    v_mfma_f32_32x32x16_bf16 v[176:191], v[200:203], v[88:91], v[176:191]
    ds_read_b64_tr_b16 v[196:197], v238 offset:43008
    ds_read_b64_tr_b16 v[198:199], v238 offset:44032
    v_mfma_f32_32x32x16_bf16 v[176:191], v[204:207], v[92:95], v[176:191]
    ds_read_b64_tr_b16 v[200:201], v238 offset:45056
    ds_read_b64_tr_b16 v[202:203], v238 offset:46080
    s_waitcnt lgkmcnt(2)
    v_mfma_f32_32x32x16_bf16 v[176:191], v[192:195], v[96:99], v[176:191]
    ds_read_b64_tr_b16 v[204:205], v238 offset:47104
    ds_read_b64_tr_b16 v[206:207], v238 offset:48128
    v_mfma_f32_32x32x16_bf16 v[176:191], v[196:199], v[100:103], v[176:191]
    ds_read_b64_tr_b16 v[192:193], v238 offset:49152
    ds_read_b64_tr_b16 v[194:195], v238 offset:50176
    s_waitcnt lgkmcnt(2)
    v_mfma_f32_32x32x16_bf16 v[176:191], v[200:203], v[104:107], v[176:191]
    ds_read_b64_tr_b16 v[196:197], v238 offset:51200
    ds_read_b64_tr_b16 v[198:199], v238 offset:52224
    v_mfma_f32_32x32x16_bf16 v[176:191], v[204:207], v[108:111], v[176:191]
    ds_read_b64_tr_b16 v[200:201], v238 offset:53248
    ds_read_b64_tr_b16 v[202:203], v238 offset:54272
    s_waitcnt lgkmcnt(2)
    v_mfma_f32_32x32x16_bf16 v[176:191], v[192:195], v[112:115], v[176:191]
    ds_read_b64_tr_b16 v[204:205], v238 offset:55296
    ds_read_b64_tr_b16 v[206:207], v238 offset:56320
    v_mfma_f32_32x32x16_bf16 v[176:191], v[196:199], v[116:119], v[176:191]
    s_waitcnt lgkmcnt(0)
    v_mfma_f32_32x32x16_bf16 v[176:191], v[200:203], v[120:123], v[176:191]
    v_mfma_f32_32x32x16_bf16 v[176:191], v[204:207], v[124:127], v[176:191]
    s_waitcnt vmcnt(0)
    s_mov_b64 exec, 1
    buffer_store_dwordx2 v[252:253], v255, s[28:31], s6 offen offset:64
    s_mov_b64 exec, -1
    v_pk_mul_f32 v[160:161], v[160:161], v[228:229] op_sel_hi:[1,0]
    v_pk_mul_f32 v[162:163], v[162:163], v[228:229] op_sel_hi:[1,0]
    v_pk_mul_f32 v[164:165], v[164:165], v[228:229] op_sel_hi:[1,0]
    v_pk_mul_f32 v[166:167], v[166:167], v[228:229] op_sel_hi:[1,0]
    v_pk_fma_f32 v[208:209], v[160:161], v[160:161], v[230:231] op_sel_hi:[1,1,0] neg_lo:[1,0,0] neg_hi:[1,0,0]
    v_pk_fma_f32 v[210:211], v[162:163], v[162:163], v[230:231] op_sel_hi:[1,1,0] neg_lo:[1,0,0] neg_hi:[1,0,0]
    v_pk_fma_f32 v[212:213], v[164:165], v[164:165], v[230:231] op_sel_hi:[1,1,0] neg_lo:[1,0,0] neg_hi:[1,0,0]
    v_pk_fma_f32 v[214:215], v[166:167], v[166:167], v[230:231] op_sel_hi:[1,1,0] neg_lo:[1,0,0] neg_hi:[1,0,0]
    v_pk_mul_f32 v[208:209], v[208:209], v[160:161]
    v_pk_mul_f32 v[210:211], v[210:211], v[162:163]
    v_pk_mul_f32 v[212:213], v[212:213], v[164:165]
    v_pk_mul_f32 v[214:215], v[214:215], v[166:167]
    v_exp_f32 v208, v208
    v_exp_f32 v209, v209
    v_exp_f32 v210, v210
    v_exp_f32 v211, v211
    v_exp_f32 v212, v212
    v_exp_f32 v213, v213
    v_exp_f32 v214, v214
    v_exp_f32 v215, v215
    v_pk_fma_f32 v[208:209], v[208:209], v[232:233], v[232:233] op_sel_hi:[1,0,0]
    v_pk_fma_f32 v[210:211], v[210:211], v[232:233], v[232:233] op_sel_hi:[1,0,0]
    v_pk_fma_f32 v[212:213], v[212:213], v[232:233], v[232:233] op_sel_hi:[1,0,0]
    v_pk_fma_f32 v[214:215], v[214:215], v[232:233], v[232:233] op_sel_hi:[1,0,0]
    v_rcp_f32 v208, v208
    v_rcp_f32 v209, v209
    v_rcp_f32 v210, v210
    v_rcp_f32 v211, v211
    v_rcp_f32 v212, v212
    v_rcp_f32 v213, v213
    v_rcp_f32 v214, v214
    v_rcp_f32 v215, v215
    v_pk_mul_f32 v[160:161], v[160:161], v[208:209]
    v_pk_mul_f32 v[162:163], v[162:163], v[210:211]
    v_pk_mul_f32 v[164:165], v[164:165], v[212:213]
    v_pk_mul_f32 v[166:167], v[166:167], v[214:215]
    v_cvt_pk_bf16_f32 v160, v160, v161
    v_cvt_pk_bf16_f32 v161, v162, v163
    v_cvt_pk_bf16_f32 v162, v164, v165
    v_cvt_pk_bf16_f32 v163, v166, v167
    buffer_store_dwordx4 v[160:163], v2, s[28:31], s5 offen offset:0 sc1
    v_pk_mul_f32 v[168:169], v[168:169], v[228:229] op_sel_hi:[1,0]
    v_pk_mul_f32 v[170:171], v[170:171], v[228:229] op_sel_hi:[1,0]
    v_pk_mul_f32 v[172:173], v[172:173], v[228:229] op_sel_hi:[1,0]
    v_pk_mul_f32 v[174:175], v[174:175], v[228:229] op_sel_hi:[1,0]
    v_pk_fma_f32 v[216:217], v[168:169], v[168:169], v[230:231] op_sel_hi:[1,1,0] neg_lo:[1,0,0] neg_hi:[1,0,0]
    v_pk_fma_f32 v[218:219], v[170:171], v[170:171], v[230:231] op_sel_hi:[1,1,0] neg_lo:[1,0,0] neg_hi:[1,0,0]
    v_pk_fma_f32 v[220:221], v[172:173], v[172:173], v[230:231] op_sel_hi:[1,1,0] neg_lo:[1,0,0] neg_hi:[1,0,0]
    v_pk_fma_f32 v[222:223], v[174:175], v[174:175], v[230:231] op_sel_hi:[1,1,0] neg_lo:[1,0,0] neg_hi:[1,0,0]
    v_pk_mul_f32 v[216:217], v[216:217], v[168:169]
    v_pk_mul_f32 v[218:219], v[218:219], v[170:171]
    v_pk_mul_f32 v[220:221], v[220:221], v[172:173]
    v_pk_mul_f32 v[222:223], v[222:223], v[174:175]
    v_exp_f32 v216, v216
    v_exp_f32 v217, v217
    v_exp_f32 v218, v218
    v_exp_f32 v219, v219
    v_exp_f32 v220, v220
    v_exp_f32 v221, v221
    v_exp_f32 v222, v222
    v_exp_f32 v223, v223
    v_pk_fma_f32 v[216:217], v[216:217], v[232:233], v[232:233] op_sel_hi:[1,0,0]
    v_pk_fma_f32 v[218:219], v[218:219], v[232:233], v[232:233] op_sel_hi:[1,0,0]
    v_pk_fma_f32 v[220:221], v[220:221], v[232:233], v[232:233] op_sel_hi:[1,0,0]
    v_pk_fma_f32 v[222:223], v[222:223], v[232:233], v[232:233] op_sel_hi:[1,0,0]
    v_rcp_f32 v216, v216
    v_rcp_f32 v217, v217
    v_rcp_f32 v218, v218
    v_rcp_f32 v219, v219
    v_rcp_f32 v220, v220
    v_rcp_f32 v221, v221
    v_rcp_f32 v222, v222
    v_rcp_f32 v223, v223
    v_pk_mul_f32 v[168:169], v[168:169], v[216:217]
    v_pk_mul_f32 v[170:171], v[170:171], v[218:219]
    v_pk_mul_f32 v[172:173], v[172:173], v[220:221]
    v_pk_mul_f32 v[174:175], v[174:175], v[222:223]
    v_cvt_pk_bf16_f32 v164, v168, v169
    v_cvt_pk_bf16_f32 v165, v170, v171
    v_cvt_pk_bf16_f32 v166, v172, v173
    v_cvt_pk_bf16_f32 v167, v174, v175
    buffer_store_dwordx4 v[164:167], v2, s[28:31], s5 offen offset:1024 sc1
    s_mul_i32 s57, s3, 28
    s_lshr_b32 s58, s57, 3
    s_lshl_b32 s56, s50, 5
    s_add_u32 s56, s56, s58
    s_lshl_b32 s56, s56, 7
    v_add_u32 v192, s56, v14
    v_add_u32_e64 v193, 64, v192
    v_cndmask_b32 v193, v193, v192, s[60:61]
    s_mov_b32 s56, 0x60000
    s_mov_b64 exec, 0xff
    buffer_load_dwordx2 v[194:195], v193, s[28:31], s56 offen sc1
    s_mov_b64 exec, -1
    s_mul_i32 s58, s64, 112
    s_add_u32 s58, s58, s57
    s_lshl_b32 s58, s58, 10
    s_add_u32 s58, s58, 9437184
    s_mul_i32 s59, s65, 112
    s_add_u32 s59, s59, s57
    s_lshl_b32 s59, s59, 10
    s_add_u32 s59, s59, 9437184
    v_pk_mul_f32 v[176:177], v[176:177], v[228:229] op_sel_hi:[1,0]
    v_pk_mul_f32 v[178:179], v[178:179], v[228:229] op_sel_hi:[1,0]
    v_pk_mul_f32 v[180:181], v[180:181], v[228:229] op_sel_hi:[1,0]
    v_pk_mul_f32 v[182:183], v[182:183], v[228:229] op_sel_hi:[1,0]
    v_pk_fma_f32 v[208:209], v[176:177], v[176:177], v[230:231] op_sel_hi:[1,1,0] neg_lo:[1,0,0] neg_hi:[1,0,0]
    v_pk_fma_f32 v[210:211], v[178:179], v[178:179], v[230:231] op_sel_hi:[1,1,0] neg_lo:[1,0,0] neg_hi:[1,0,0]
    v_pk_fma_f32 v[212:213], v[180:181], v[180:181], v[230:231] op_sel_hi:[1,1,0] neg_lo:[1,0,0] neg_hi:[1,0,0]
    v_pk_fma_f32 v[214:215], v[182:183], v[182:183], v[230:231] op_sel_hi:[1,1,0] neg_lo:[1,0,0] neg_hi:[1,0,0]
    v_pk_mul_f32 v[208:209], v[208:209], v[176:177]
    v_pk_mul_f32 v[210:211], v[210:211], v[178:179]
    v_pk_mul_f32 v[212:213], v[212:213], v[180:181]
    v_pk_mul_f32 v[214:215], v[214:215], v[182:183]
    v_exp_f32 v208, v208
    v_exp_f32 v209, v209
    v_exp_f32 v210, v210
    v_exp_f32 v211, v211
    v_exp_f32 v212, v212
    v_exp_f32 v213, v213
    v_exp_f32 v214, v214
    v_exp_f32_e64 v215, v215
    v_pk_fma_f32 v[208:209], v[208:209], v[232:233], v[232:233] op_sel_hi:[1,0,0]
    v_pk_fma_f32 v[210:211], v[210:211], v[232:233], v[232:233] op_sel_hi:[1,0,0]
    v_pk_fma_f32 v[212:213], v[212:213], v[232:233], v[232:233] op_sel_hi:[1,0,0]
    v_pk_fma_f32 v[214:215], v[214:215], v[232:233], v[232:233] op_sel_hi:[1,0,0]
    v_rcp_f32 v208, v208
    v_rcp_f32 v209, v209
    v_rcp_f32 v210, v210
    v_rcp_f32 v211, v211
    v_rcp_f32 v212, v212
    v_rcp_f32 v213, v213
    v_rcp_f32 v214, v214
    v_rcp_f32 v215, v215
    v_pk_mul_f32 v[176:177], v[176:177], v[208:209]
    v_pk_mul_f32 v[178:179], v[178:179], v[210:211]
    v_pk_mul_f32 v[180:181], v[180:181], v[212:213]
    v_pk_mul_f32 v[182:183], v[182:183], v[214:215]
    v_cvt_pk_bf16_f32 v176, v176, v177
    v_cvt_pk_bf16_f32 v177, v178, v179
    v_cvt_pk_bf16_f32 v178, v180, v181
    v_cvt_pk_bf16_f32 v179, v182, v183
    buffer_store_dwordx4 v[176:179], v2, s[28:31], s5 offen offset:2048 sc1
    v_pk_mul_f32 v[184:185], v[184:185], v[228:229] op_sel_hi:[1,0]
    v_pk_mul_f32 v[186:187], v[186:187], v[228:229] op_sel_hi:[1,0]
    v_pk_mul_f32 v[188:189], v[188:189], v[228:229] op_sel_hi:[1,0]
    v_pk_mul_f32 v[190:191], v[190:191], v[228:229] op_sel_hi:[1,0]
    v_pk_fma_f32 v[216:217], v[184:185], v[184:185], v[230:231] op_sel_hi:[1,1,0] neg_lo:[1,0,0] neg_hi:[1,0,0]
    v_pk_fma_f32 v[218:219], v[186:187], v[186:187], v[230:231] op_sel_hi:[1,1,0] neg_lo:[1,0,0] neg_hi:[1,0,0]
    v_pk_fma_f32 v[220:221], v[188:189], v[188:189], v[230:231] op_sel_hi:[1,1,0] neg_lo:[1,0,0] neg_hi:[1,0,0]
    v_pk_fma_f32 v[222:223], v[190:191], v[190:191], v[230:231] op_sel_hi:[1,1,0] neg_lo:[1,0,0] neg_hi:[1,0,0]
    v_pk_mul_f32 v[216:217], v[216:217], v[184:185]
    v_pk_mul_f32 v[218:219], v[218:219], v[186:187]
    v_pk_mul_f32 v[220:221], v[220:221], v[188:189]
    v_pk_mul_f32 v[222:223], v[222:223], v[190:191]
    v_exp_f32 v216, v216
    v_exp_f32 v217, v217
    v_exp_f32 v218, v218
    v_exp_f32 v219, v219
    v_exp_f32 v220, v220
    v_exp_f32 v221, v221
    v_exp_f32 v222, v222
    v_exp_f32 v223, v223
    v_pk_fma_f32 v[216:217], v[216:217], v[232:233], v[232:233] op_sel_hi:[1,0,0]
    v_pk_fma_f32 v[218:219], v[218:219], v[232:233], v[232:233] op_sel_hi:[1,0,0]
    v_pk_fma_f32 v[220:221], v[220:221], v[232:233], v[232:233] op_sel_hi:[1,0,0]
    v_pk_fma_f32 v[222:223], v[222:223], v[232:233], v[232:233] op_sel_hi:[1,0,0]
    v_rcp_f32 v216, v216
    v_rcp_f32 v217, v217
    v_rcp_f32 v218, v218
    v_rcp_f32 v219, v219
    v_rcp_f32 v220, v220
    v_rcp_f32 v221, v221
    v_rcp_f32 v222, v222
    v_rcp_f32 v223, v223
    v_pk_mul_f32 v[184:185], v[184:185], v[216:217]
    v_pk_mul_f32 v[186:187], v[186:187], v[218:219]
    v_pk_mul_f32 v[188:189], v[188:189], v[220:221]
    v_pk_mul_f32 v[190:191], v[190:191], v[222:223]
    v_cvt_pk_bf16_f32 v180, v184, v185
    v_cvt_pk_bf16_f32 v181, v186, v187
    v_cvt_pk_bf16_f32 v182, v188, v189
    v_cvt_pk_bf16_f32 v183, v190, v191
    buffer_store_dwordx4 v[180:183], v2, s[28:31], s5 offen offset:3072 sc1
    s_waitcnt vmcnt(2)
    v_cmp_eq_u64 vcc, s[54:55], v[194:195]
    s_nop 0
    s_and_b32 vcc_lo, vcc_lo, 0xff
    s_cmp_eq_u32 vcc_lo, 0xff
    s_cselect_b32 s81, 1, 0
    s_cbranch_scc0 L_nopre_13
    s_add_u32 s7, s59, s84
    buffer_load_dwordx4 v[80:83], v2, s[28:31], s7 offen offset:0 sc1
    buffer_load_dwordx4 v[84:87], v2, s[28:31], s7 offen offset:1024 sc1
    buffer_load_dwordx4 v[88:91], v2, s[28:31], s7 offen offset:2048 sc1
    buffer_load_dwordx4 v[92:95], v2, s[28:31], s7 offen offset:3072 sc1
    s_add_u32 s7, s59, s85
    buffer_load_dwordx4 v[96:99], v2, s[28:31], s7 offen offset:0 sc1
    buffer_load_dwordx4 v[100:103], v2, s[28:31], s7 offen offset:1024 sc1
    buffer_load_dwordx4 v[104:107], v2, s[28:31], s7 offen offset:2048 sc1
    buffer_load_dwordx4 v[108:111], v2, s[28:31], s7 offen offset:3072 sc1
    s_add_u32 s7, s59, s86
    buffer_load_dwordx4 v[112:115], v2, s[28:31], s7 offen offset:0 sc1
    buffer_load_dwordx4 v[116:119], v2, s[28:31], s7 offen offset:1024 sc1
L_nopre_13:
    s_mul_i32 s4, s64, 28672
    s_add_u32 s4, s4, s83
    v_lshrrev_b32 v197, 5, v1
    v_and_b32_e64 v196, 31, v1
    v_mul_u32_u24 v196, 896, v196
    v_lshl_add_u32 v196, v197, 4, v196
    s_cmp_eq_u32 s81, 1
    s_cbranch_scc1 L_go_14
    s_waitcnt vmcnt(0)
    s_mov_b64 exec, 1
    buffer_store_dwordx2 v[252:253], v255, s[28:31], s6 offen
    s_mov_b32 s80, s6
    s_mov_b64 exec, -1
    s_mov_b32 exec_lo, 0xff
    s_mov_b32 exec_hi, 0
    s_mov_b32 s56, 0x60000
    s_mov_b32 s74, 30
L_poll_15:
    buffer_load_dwordx2 v[194:195], v193, s[28:31], s56 offen sc1
    s_waitcnt vmcnt(0)
    v_cmp_ne_u64 vcc, s[54:55], v[194:195]
    s_cbranch_vccz L_pollok_16
    s_sub_u32 s74, s74, 1
    s_cbranch_scc0 L_poll_15
    s_mov_b64 exec, 1
    v_mov_b32 v248, s54
    v_mov_b32 v249, s55
    v_mov_b32_e64 v250, 0
    buffer_store_dwordx2 v[248:249], v250, s[28:31], s80 offen sc1
    s_mov_b32 s80, 0x7ffffff0
    s_mov_b32 exec_lo, 0xff
    s_mov_b32 exec_hi, 0xff
    s_mov_b32 s74, 0x400000
L_pollg_17:
    buffer_load_dwordx2 v[194:195], v193, s[28:31], s56 offen sc1
    s_sub_u32 s74, s74, 1
    s_cbranch_scc1 L_pollok_16
    s_waitcnt vmcnt(0)
    v_cmp_eq_u64 vcc, s[54:55], v[194:195]
    s_nop 0
    s_or_b32 vcc_lo, vcc_lo, vcc_hi
    s_cmp_lg_u32 vcc_lo, 0xff
    s_cbranch_scc1 L_pollg_17
L_pollok_16:
    s_waitcnt vmcnt(0)
    s_mov_b64 exec, -1
    s_add_u32 s7, s59, s84
    buffer_load_dwordx4 v[80:83], v2, s[28:31], s7 offen offset:0 sc1
    buffer_load_dwordx4 v[84:87], v2, s[28:31], s7 offen offset:1024 sc1
    buffer_load_dwordx4 v[88:91], v2, s[28:31], s7 offen offset:2048 sc1
    buffer_load_dwordx4 v[92:95], v2, s[28:31], s7 offen offset:3072 sc1
    s_add_u32 s7, s59, s85
    buffer_load_dwordx4 v[96:99], v2, s[28:31], s7 offen offset:0 sc1
    buffer_load_dwordx4 v[100:103], v2, s[28:31], s7 offen offset:1024 sc1
    buffer_load_dwordx4 v[104:107], v2, s[28:31], s7 offen offset:2048 sc1
    buffer_load_dwordx4 v[108:111], v2, s[28:31], s7 offen offset:3072 sc1
    s_add_u32 s7, s59, s86
    buffer_load_dwordx4 v[112:115], v2, s[28:31], s7 offen offset:0 sc1
    buffer_load_dwordx4 v[116:119], v2, s[28:31], s7 offen offset:1024 sc1
L_go_14:
    v_lshlrev_b32_e64 v16, 16, v240
    v_and_b32 v17, 0xffff0000, v240
    v_lshlrev_b32_e64 v18, 16, v241
    v_and_b32 v19, 0xffff0000, v241
    v_lshlrev_b32_e64 v20, 16, v242
    v_and_b32 v21, 0xffff0000, v242
    v_lshlrev_b32_e64 v22, 16, v243
    v_and_b32 v23, 0xffff0000, v243
    v_lshlrev_b32_e64 v24, 16, v244
    v_and_b32 v25, 0xffff0000, v244
    v_lshlrev_b32_e64 v26, 16, v245
    v_and_b32 v27, 0xffff0000, v245
    v_lshlrev_b32_e64 v28, 16, v246
    v_and_b32 v29, 0xffff0000, v246
    v_lshlrev_b32_e64 v30, 16, v247
    v_and_b32 v31, 0xffff0000, v247
    v_mov_b32_e64 v200, v251
    v_mov_b32 v204, 0x3f80
    v_mov_b32 v201, 0
    v_mov_b32 v202, 0
    v_mov_b32 v203, 0
    v_mov_b32 v205, 0
    v_mov_b32 v206, 0
    v_mov_b32 v207, 0
    v_cndmask_b32 v204, v204, 0, s[60:61]
    s_nop 1
    v_mfma_f32_32x32x16_bf16 v[16:31], v[200:203], v[204:207], v[16:31]
    s_waitcnt vmcnt(10)
    s_mov_b64 exec, 1
    buffer_store_dwordx2 v[252:253], v255, s[28:31], s6 offen
    s_mov_b32 s80, s6
    s_mov_b64 exec, -1
    s_waitcnt vmcnt(10)
    v_mfma_f32_32x32x16_bf16 v[64:79], a[4:7], v[80:83], 0
    buffer_load_dwordx4 v[120:123], v2, s[28:31], s7 offen offset:2048 sc1
    v_mfma_f32_32x32x16_bf16 v[48:63], a[0:3], v[80:83], 0
    s_waitcnt vmcnt(10)
    v_mfma_f32_32x32x16_bf16 v[64:79], a[12:15], v[84:87], v[64:79]
    buffer_load_dwordx4 v[124:127], v2, s[28:31], s7 offen offset:3072 sc1
    v_mfma_f32_32x32x16_bf16 v[48:63], a[8:11], v[84:87], v[48:63]
    s_waitcnt vmcnt(10)
    v_mfma_f32_32x32x16_bf16 v[64:79], a[20:23], v[88:91], v[64:79]
    s_add_u32 s7, s58, s84
    buffer_load_dwordx4 v[128:131], v2, s[28:31], s7 offen offset:0 sc1
    v_mfma_f32_32x32x16_bf16 v[48:63], a[16:19], v[88:91], v[48:63]
    s_waitcnt vmcnt(10)
    v_mfma_f32_32x32x16_bf16 v[64:79], a[28:31], v[92:95], v[64:79]
    buffer_load_dwordx4 v[132:135], v2, s[28:31], s7 offen offset:1024 sc1
    v_mfma_f32_32x32x16_bf16 v[48:63], a[24:27], v[92:95], v[48:63]
    s_waitcnt vmcnt(10)
    v_mfma_f32_32x32x16_bf16 v[64:79], a[36:39], v[96:99], v[64:79]
    buffer_load_dwordx4 v[136:139], v2, s[28:31], s7 offen offset:2048 sc1
    v_mfma_f32_32x32x16_bf16 v[48:63], a[32:35], v[96:99], v[48:63]
    s_waitcnt vmcnt(10)
    v_mfma_f32_32x32x16_bf16 v[64:79], a[44:47], v[100:103], v[64:79]
    buffer_load_dwordx4 v[140:143], v2, s[28:31], s7 offen offset:3072 sc1
    v_mfma_f32_32x32x16_bf16 v[48:63], a[40:43], v[100:103], v[48:63]
    s_waitcnt vmcnt(10)
    v_mfma_f32_32x32x16_bf16 v[64:79], a[52:55], v[104:107], v[64:79]
    s_add_u32 s7, s58, s85
    buffer_load_dwordx4 v[144:147], v2, s[28:31], s7 offen offset:0 sc1
    v_mfma_f32_32x32x16_bf16 v[48:63], a[48:51], v[104:107], v[48:63]
    s_waitcnt vmcnt(10)
    v_mfma_f32_32x32x16_bf16 v[64:79], a[60:63], v[108:111], v[64:79]
    buffer_load_dwordx4 v[148:151], v2, s[28:31], s7 offen offset:1024 sc1
    v_mfma_f32_32x32x16_bf16 v[48:63], a[56:59], v[108:111], v[48:63]
    s_waitcnt vmcnt(10)
    v_mfma_f32_32x32x16_bf16 v[64:79], a[68:71], v[112:115], v[64:79]
    buffer_load_dwordx4 v[152:155], v2, s[28:31], s7 offen offset:2048 sc1
    v_mfma_f32_32x32x16_bf16 v[48:63], a[64:67], v[112:115], v[48:63]
    s_mov_b64 exec, 0xff
    buffer_load_dwordx2 v[194:195], v192, s[28:31], s56 offen sc1
    s_mov_b64 exec, -1
    s_waitcnt vmcnt(11)
    v_mfma_f32_32x32x16_bf16 v[64:79], a[76:79], v[116:119], v[64:79]
    buffer_load_dwordx4 v[156:159], v2, s[28:31], s7 offen offset:3072 sc1
    v_mfma_f32_32x32x16_bf16 v[48:63], a[72:75], v[116:119], v[48:63]
    s_waitcnt vmcnt(10)
    v_mfma_f32_32x32x16_bf16 v[64:79], a[84:87], v[120:123], v[64:79]
    s_add_u32 s7, s58, s86
    buffer_load_dwordx4 v[160:163], v2, s[28:31], s7 offen offset:0 sc1
    v_mfma_f32_32x32x16_bf16 v[48:63], a[80:83], v[120:123], v[48:63]
    s_waitcnt vmcnt(10)
    v_mfma_f32_32x32x16_bf16 v[64:79], a[92:95], v[124:127], v[64:79]
    buffer_load_dwordx4 v[164:167], v2, s[28:31], s7 offen offset:1024 sc1
    v_mfma_f32_32x32x16_bf16 v[48:63], a[88:91], v[124:127], v[48:63]
    s_waitcnt vmcnt(10)
    v_mfma_f32_32x32x16_bf16 v[32:47], a[4:7], v[128:131], 0
    buffer_load_dwordx4 v[168:171], v2, s[28:31], s7 offen offset:2048 sc1
    v_mfma_f32_32x32x16_bf16 v[16:31], a[0:3], v[128:131], v[16:31]
    s_waitcnt vmcnt(10)
    v_mfma_f32_32x32x16_bf16 v[32:47], a[12:15], v[132:135], v[32:47]
    buffer_load_dwordx4 v[172:175], v2, s[28:31], s7 offen offset:3072 sc1
    v_mfma_f32_32x32x16_bf16 v[16:31], a[8:11], v[132:135], v[16:31]
    s_waitcnt vmcnt(10)
    v_mfma_f32_32x32x16_bf16 v[32:47], a[20:23], v[136:139], v[32:47]
    s_waitcnt vmcnt(5)
    v_cmp_eq_u64 vcc, s[54:55], v[194:195]
    s_nop 0
    s_and_b32 vcc_lo, vcc_lo, 0xff
    s_cmp_eq_u32 vcc_lo, 0xff
    s_cbranch_scc1 L_lok_18
    s_mov_b32 exec_lo, 0xff
    s_mov_b32 exec_hi, 0
    s_mov_b32 s56, 0x60000
    s_mov_b32 s74, 30
    s_nop 1
L_poll_19:
    buffer_load_dwordx2 v[194:195], v192, s[28:31], s56 offen sc1
    s_waitcnt vmcnt(0)
    v_cmp_ne_u64 vcc, s[54:55], v[194:195]
    s_cbranch_vccz L_pollok_20
    s_sub_u32 s74, s74, 1
    s_cbranch_scc0 L_poll_19
    s_mov_b64 exec, 1
    v_mov_b32 v248, s54
    v_mov_b32 v249, s55
    v_mov_b32 v250, 0
    buffer_store_dwordx2 v[248:249], v250, s[28:31], s80 offen sc1
    s_mov_b32 s80, 0x7ffffff0
    s_mov_b32 exec_lo, 0xff
    s_mov_b32 exec_hi, 0xff
    s_mov_b32 s74, 0x400000
L_pollg_21:
    buffer_load_dwordx2 v[194:195], v192, s[28:31], s56 offen sc1
    s_sub_u32 s74, s74, 1
    s_cbranch_scc1 L_pollok_20
    s_waitcnt vmcnt(0)
    v_cmp_eq_u64 vcc, s[54:55], v[194:195]
    s_nop 0
    s_or_b32 vcc_lo, vcc_lo, vcc_hi
    s_cmp_lg_u32 vcc_lo, 0xff
    s_cbranch_scc1 L_pollg_21
L_pollok_20:
    s_waitcnt vmcnt(0)
    s_mov_b64 exec, -1
L_lok_18:
    s_add_u32 s7, s59, s87
    buffer_load_dwordx4 v[176:179], v2, s[28:31], s7 offen offset:0 sc1
    v_mfma_f32_32x32x16_bf16 v[16:31], a[16:19], v[136:139], v[16:31]
    v_mfma_f32_32x32x16_bf16 v[32:47], a[28:31], v[140:143], v[32:47]
    buffer_load_dwordx4 v[180:183], v2, s[28:31], s7 offen offset:1024 sc1
    v_mfma_f32_32x32x16_bf16 v[16:31], a[24:27], v[140:143], v[16:31]
    v_mfma_f32_32x32x16_bf16 v[32:47], a[36:39], v[144:147], v[32:47]
    buffer_load_dwordx4 v[184:187], v2, s[28:31], s7 offen offset:2048 sc1
    v_mfma_f32_32x32x16_bf16 v[16:31], a[32:35], v[144:147], v[16:31]
    v_mfma_f32_32x32x16_bf16 v[32:47], a[44:47], v[148:151], v[32:47]
    buffer_load_dwordx4 v[188:191], v2, s[28:31], s7 offen offset:3072 sc1
    v_mfma_f32_32x32x16_bf16 v[16:31], a[40:43], v[148:151], v[16:31]
    v_mfma_f32_32x32x16_bf16 v[32:47], a[52:55], v[152:155], v[32:47]
    s_add_u32 s7, s59, s88
    buffer_load_dwordx4 v[80:83], v2, s[28:31], s7 offen offset:0 sc1
    v_mfma_f32_32x32x16_bf16 v[16:31], a[48:51], v[152:155], v[16:31]
    s_waitcnt vmcnt(9)
    v_mfma_f32_32x32x16_bf16 v[32:47], a[60:63], v[156:159], v[32:47]
    buffer_load_dwordx4 v[84:87], v2, s[28:31], s7 offen offset:1024 sc1
    v_mfma_f32_32x32x16_bf16 v[16:31], a[56:59], v[156:159], v[16:31]
    s_waitcnt vmcnt(9)
    v_mfma_f32_32x32x16_bf16 v[32:47], a[68:71], v[160:163], v[32:47]
    buffer_load_dwordx4 v[88:91], v2, s[28:31], s7 offen offset:2048 sc1
    v_mfma_f32_32x32x16_bf16 v[16:31], a[64:67], v[160:163], v[16:31]
    s_waitcnt vmcnt(9)
    v_mfma_f32_32x32x16_bf16 v[32:47], a[76:79], v[164:167], v[32:47]
    buffer_load_dwordx4 v[92:95], v2, s[28:31], s7 offen offset:3072 sc1
    v_mfma_f32_32x32x16_bf16 v[16:31], a[72:75], v[164:167], v[16:31]
    s_waitcnt vmcnt(9)
    v_mfma_f32_32x32x16_bf16 v[32:47], a[84:87], v[168:171], v[32:47]
    s_add_u32 s7, s59, s89
    buffer_load_dwordx4 v[96:99], v2, s[28:31], s7 offen offset:0 sc1
    v_mfma_f32_32x32x16_bf16 v[16:31], a[80:83], v[168:171], v[16:31]
    s_waitcnt vmcnt(9)
    v_mfma_f32_32x32x16_bf16 v[32:47], a[92:95], v[172:175], v[32:47]
    buffer_load_dwordx4 v[100:103], v2, s[28:31], s7 offen offset:1024 sc1
    v_mfma_f32_32x32x16_bf16 v[16:31], a[88:91], v[172:175], v[16:31]
    s_waitcnt vmcnt(9)
    v_mfma_f32_32x32x16_bf16 v[64:79], a[100:103], v[176:179], v[64:79]
    buffer_load_dwordx4 v[104:107], v2, s[28:31], s7 offen offset:2048 sc1
    v_mfma_f32_32x32x16_bf16 v[48:63], a[96:99], v[176:179], v[48:63]
    s_waitcnt vmcnt(9)
    v_mfma_f32_32x32x16_bf16 v[64:79], a[108:111], v[180:183], v[64:79]
    buffer_load_dwordx4 v[108:111], v2, s[28:31], s7 offen offset:3072 sc1
    v_mfma_f32_32x32x16_bf16 v[48:63], a[104:107], v[180:183], v[48:63]
    s_waitcnt vmcnt(9)
    v_mfma_f32_32x32x16_bf16 v[64:79], a[116:119], v[184:187], v[64:79]
    s_add_u32 s7, s59, s90
    buffer_load_dwordx4 v[112:115], v2, s[28:31], s7 offen offset:0 sc1
    v_mfma_f32_32x32x16_bf16 v[48:63], a[112:115], v[184:187], v[48:63]
    s_waitcnt vmcnt(9)
    v_mfma_f32_32x32x16_bf16 v[64:79], a[124:127], v[188:191], v[64:79]
    buffer_load_dwordx4 v[116:119], v2, s[28:31], s7 offen offset:1024 sc1
    v_mfma_f32_32x32x16_bf16 v[48:63], a[120:123], v[188:191], v[48:63]
    s_waitcnt vmcnt(9)
    v_mfma_f32_32x32x16_bf16 v[64:79], a[132:135], v[80:83], v[64:79]
    buffer_load_dwordx4 v[120:123], v2, s[28:31], s7 offen offset:2048 sc1
    v_mfma_f32_32x32x16_bf16 v[48:63], a[128:131], v[80:83], v[48:63]
    s_waitcnt vmcnt(9)
    v_mfma_f32_32x32x16_bf16 v[64:79], a[140:143], v[84:87], v[64:79]
    buffer_load_dwordx4 v[124:127], v2, s[28:31], s7 offen offset:3072 sc1
    v_mfma_f32_32x32x16_bf16 v[48:63], a[136:139], v[84:87], v[48:63]
    s_waitcnt vmcnt(9)
    v_mfma_f32_32x32x16_bf16 v[64:79], a[148:151], v[88:91], v[64:79]
    s_add_u32 s7, s58, s87
    buffer_load_dwordx4 v[128:131], v2, s[28:31], s7 offen offset:0 sc1
    v_mfma_f32_32x32x16_bf16 v[48:63], a[144:147], v[88:91], v[48:63]
    s_waitcnt vmcnt(9)
    v_mfma_f32_32x32x16_bf16 v[64:79], a[156:159], v[92:95], v[64:79]
    buffer_load_dwordx4 v[132:135], v2, s[28:31], s7 offen offset:1024 sc1
    v_mfma_f32_32x32x16_bf16 v[48:63], a[152:155], v[92:95], v[48:63]
    s_waitcnt vmcnt(9)
    v_mfma_f32_32x32x16_bf16 v[64:79], a[164:167], v[96:99], v[64:79]
    buffer_load_dwordx4 v[136:139], v2, s[28:31], s7 offen offset:2048 sc1
    v_mfma_f32_32x32x16_bf16 v[48:63], a[160:163], v[96:99], v[48:63]
    s_waitcnt vmcnt(9)
    v_mfma_f32_32x32x16_bf16 v[64:79], a[172:175], v[100:103], v[64:79]
    buffer_load_dwordx4 v[140:143], v2, s[28:31], s7 offen offset:3072 sc1
    v_mfma_f32_32x32x16_bf16 v[48:63], a[168:171], v[100:103], v[48:63]
    s_waitcnt vmcnt(9)
    v_mfma_f32_32x32x16_bf16 v[64:79], a[180:183], v[104:107], v[64:79]
    s_add_u32 s7, s58, s88
    buffer_load_dwordx4 v[144:147], v2, s[28:31], s7 offen offset:0 sc1
    v_mfma_f32_32x32x16_bf16 v[48:63], a[176:179], v[104:107], v[48:63]
    s_waitcnt vmcnt(9)
    v_mfma_f32_32x32x16_bf16 v[64:79], a[188:191], v[108:111], v[64:79]
    buffer_load_dwordx4 v[148:151], v2, s[28:31], s7 offen offset:1024 sc1
    v_mfma_f32_32x32x16_bf16 v[48:63], a[184:187], v[108:111], v[48:63]
    s_waitcnt vmcnt(9)
    v_mfma_f32_32x32x16_bf16 v[64:79], a[196:199], v[112:115], v[64:79]
    buffer_load_dwordx4 v[152:155], v2, s[28:31], s7 offen offset:2048 sc1
    v_mfma_f32_32x32x16_bf16 v[48:63], a[192:195], v[112:115], v[48:63]
    s_waitcnt vmcnt(9)
    v_mfma_f32_32x32x16_bf16 v[64:79], a[204:207], v[116:119], v[64:79]
    buffer_load_dwordx4 v[156:159], v2, s[28:31], s7 offen offset:3072 sc1
    v_mfma_f32_32x32x16_bf16 v[48:63], a[200:203], v[116:119], v[48:63]
    s_waitcnt vmcnt(9)
    v_mfma_f32_32x32x16_bf16 v[64:79], a[212:215], v[120:123], v[64:79]
    s_add_u32 s7, s58, s89
    buffer_load_dwordx4 v[160:163], v2, s[28:31], s7 offen offset:0 sc1
    v_mfma_f32_32x32x16_bf16 v[48:63], a[208:211], v[120:123], v[48:63]
    s_waitcnt vmcnt(9)
    v_mfma_f32_32x32x16_bf16 v[64:79], a[220:223], v[124:127], v[64:79]
    buffer_load_dwordx4 v[164:167], v2, s[28:31], s7 offen offset:1024 sc1
    v_mfma_f32_32x32x16_bf16 v[48:63], a[216:219], v[124:127], v[48:63]
    s_waitcnt vmcnt(9)
    v_mfma_f32_32x32x16_bf16 v[32:47], a[100:103], v[128:131], v[32:47]
    buffer_load_dwordx4 v[168:171], v2, s[28:31], s7 offen offset:2048 sc1
    v_mfma_f32_32x32x16_bf16 v[16:31], a[96:99], v[128:131], v[16:31]
    s_waitcnt vmcnt(9)
    v_mfma_f32_32x32x16_bf16 v[32:47], a[108:111], v[132:135], v[32:47]
    buffer_load_dwordx4 v[172:175], v2, s[28:31], s7 offen offset:3072 sc1
    v_mfma_f32_32x32x16_bf16 v[16:31], a[104:107], v[132:135], v[16:31]
    s_waitcnt vmcnt(9)
    v_mfma_f32_32x32x16_bf16 v[32:47], a[116:119], v[136:139], v[32:47]
    s_add_u32 s7, s58, s90
    buffer_load_dwordx4 v[176:179], v2, s[28:31], s7 offen offset:0 sc1
    v_mfma_f32_32x32x16_bf16 v[16:31], a[112:115], v[136:139], v[16:31]
    s_waitcnt vmcnt(9)
    v_mfma_f32_32x32x16_bf16 v[32:47], a[124:127], v[140:143], v[32:47]
    buffer_load_dwordx4 v[180:183], v2, s[28:31], s7 offen offset:1024 sc1
    v_mfma_f32_32x32x16_bf16 v[16:31], a[120:123], v[140:143], v[16:31]
    s_waitcnt vmcnt(9)
    v_mfma_f32_32x32x16_bf16 v[32:47], a[132:135], v[144:147], v[32:47]
    buffer_load_dwordx4 v[184:187], v2, s[28:31], s7 offen offset:2048 sc1
    v_mfma_f32_32x32x16_bf16 v[16:31], a[128:131], v[144:147], v[16:31]
    s_waitcnt vmcnt(9)
    v_mfma_f32_32x32x16_bf16 v[32:47], a[140:143], v[148:151], v[32:47]
    buffer_load_dwordx4 v[188:191], v2, s[28:31], s7 offen offset:3072 sc1
    v_mfma_f32_32x32x16_bf16 v[16:31], a[136:139], v[148:151], v[16:31]
    s_mov_b64 exec, 1
    v_mov_b32 v248, s54
    v_mov_b32 v249, s55
    v_mov_b32 v250, 0
    buffer_store_dwordx2 v[248:249], v250, s[28:31], s80 offen sc1
    s_mov_b32 s80, 0x7ffffff0
    s_mov_b64 exec, -1
    s_waitcnt vmcnt(10)
    v_mfma_f32_32x32x16_bf16 v[32:47], a[148:151], v[152:155], v[32:47]
    s_barrier
    v_mfma_f32_32x32x16_bf16 v[16:31], a[144:147], v[152:155], v[16:31]
    ds_write_b128 v10, v[64:67] offset:8192
    s_waitcnt vmcnt(9)
    v_mfma_f32_32x32x16_bf16 v[32:47], a[156:159], v[156:159], v[32:47]
    ds_write_b128 v10, v[68:71] offset:9216
    v_mfma_f32_32x32x16_bf16 v[16:31], a[152:155], v[156:159], v[16:31]
    ds_write_b128 v10, v[72:75] offset:10240
    s_waitcnt vmcnt(8)
    v_mfma_f32_32x32x16_bf16 v[32:47], a[164:167], v[160:163], v[32:47]
    ds_write_b128 v10, v[76:79] offset:11264
    v_mfma_f32_32x32x16_bf16 v[16:31], a[160:163], v[160:163], v[16:31]
    ds_write_b128 v10, v[48:51] offset:4096
    s_waitcnt vmcnt(7)
    v_mfma_f32_32x32x16_bf16 v[32:47], a[172:175], v[164:167], v[32:47]
    ds_write_b128 v10, v[52:55] offset:5120
    v_mfma_f32_32x32x16_bf16 v[16:31], a[168:171], v[164:167], v[16:31]
    ds_write_b128 v10, v[56:59] offset:6144
    s_waitcnt vmcnt(6)
    v_mfma_f32_32x32x16_bf16 v[32:47], a[180:183], v[168:171], v[32:47]
    ds_write_b128 v10, v[60:63] offset:7168
    v_mfma_f32_32x32x16_bf16 v[16:31], a[176:179], v[168:171], v[16:31]
    s_waitcnt vmcnt(5)
    v_mfma_f32_32x32x16_bf16 v[32:47], a[188:191], v[172:175], v[32:47]
    v_mfma_f32_32x32x16_bf16 v[16:31], a[184:187], v[172:175], v[16:31]
    s_waitcnt vmcnt(4)
    v_mfma_f32_32x32x16_bf16 v[32:47], a[196:199], v[176:179], v[32:47]
    v_mfma_f32_32x32x16_bf16 v[16:31], a[192:195], v[176:179], v[16:31]
    s_waitcnt vmcnt(3)
    v_mfma_f32_32x32x16_bf16 v[32:47], a[204:207], v[180:183], v[32:47]
    v_mfma_f32_32x32x16_bf16 v[16:31], a[200:203], v[180:183], v[16:31]
    s_waitcnt vmcnt(2)
    v_mfma_f32_32x32x16_bf16 v[32:47], a[212:215], v[184:187], v[32:47]
    v_mfma_f32_32x32x16_bf16 v[16:31], a[208:211], v[184:187], v[16:31]
    s_waitcnt vmcnt(1)
    v_mfma_f32_32x32x16_bf16 v[32:47], a[220:223], v[188:191], v[32:47]
    v_mfma_f32_32x32x16_bf16 v[16:31], a[216:219], v[188:191], v[16:31]
    s_nop 10
    ds_write_b128 v10, v[32:35] offset:0
    ds_write_b128 v10, v[36:39] offset:1024
    ds_write_b128 v10, v[40:43] offset:2048
    ds_write_b128 v10, v[44:47] offset:3072
    s_waitcnt lgkmcnt(0)
    s_barrier
    ds_read_b128 v[64:67], v13 offset:0
    ds_read_b128 v[68:71], v13 offset:1024
    ds_read_b128 v[72:75], v13 offset:2048
    ds_read_b128 v[76:79], v13 offset:3072
    ds_read_b128 v[48:51], v12 offset:0
    ds_read_b128 v[52:55], v12 offset:1024
    ds_read_b128 v[56:59], v12 offset:2048
    ds_read_b128 v[60:63], v12 offset:3072
    ds_read_b128 v[32:35], v11 offset:0
    ds_read_b128 v[36:39], v11 offset:1024
    ds_read_b128 v[40:43], v11 offset:2048
    ds_read_b128 v[44:47], v11 offset:3072
    s_waitcnt lgkmcnt(8)
    v_pk_add_f32 v[16:17], v[16:17], v[64:65]
    v_pk_add_f32 v[18:19], v[18:19], v[66:67]
    v_pk_add_f32 v[20:21], v[20:21], v[68:69]
    v_pk_add_f32 v[22:23], v[22:23], v[70:71]
    v_pk_add_f32 v[24:25], v[24:25], v[72:73]
    v_pk_add_f32 v[26:27], v[26:27], v[74:75]
    v_pk_add_f32 v[28:29], v[28:29], v[76:77]
    v_pk_add_f32 v[30:31], v[30:31], v[78:79]
    s_waitcnt lgkmcnt(4)
    v_pk_add_f32 v[16:17], v[16:17], v[48:49]
    v_pk_add_f32 v[18:19], v[18:19], v[50:51]
    v_pk_add_f32 v[20:21], v[20:21], v[52:53]
    v_pk_add_f32 v[22:23], v[22:23], v[54:55]
    v_pk_add_f32 v[24:25], v[24:25], v[56:57]
    v_pk_add_f32 v[26:27], v[26:27], v[58:59]
    v_pk_add_f32 v[28:29], v[28:29], v[60:61]
    v_pk_add_f32 v[30:31], v[30:31], v[62:63]
    s_waitcnt lgkmcnt(0)
    v_pk_add_f32 v[16:17], v[16:17], v[32:33]
    v_pk_add_f32 v[18:19], v[18:19], v[34:35]
    v_pk_add_f32 v[20:21], v[20:21], v[36:37]
    v_pk_add_f32 v[22:23], v[22:23], v[38:39]
    v_pk_add_f32 v[24:25], v[24:25], v[40:41]
    v_pk_add_f32 v[26:27], v[26:27], v[42:43]
    v_pk_add_f32 v[28:29], v[28:29], v[44:45]
    v_pk_add_f32 v[30:31], v[30:31], v[46:47]
    v_cvt_pk_bf16_f32 v80, v16, v17
    v_cvt_pk_bf16_f32 v81, v18, v19
    v_cvt_pk_bf16_f32 v82, v20, v21
    v_cvt_pk_bf16_f32 v83, v22, v23
    v_cvt_pk_bf16_f32 v84, v24, v25
    v_cvt_pk_bf16_f32 v85, v26, v27
    v_cvt_pk_bf16_f32 v86, v28, v29
    v_cvt_pk_bf16_f32 v87, v30, v31
    v_permlane32_swap_b32 v80, v82
    v_permlane32_swap_b32 v81, v83
    buffer_store_dwordx4 v[80:83], v196, s[32:35], s4 offen offset:0
    v_permlane32_swap_b32 v84, v86
    v_permlane32_swap_b32 v85, v87
    buffer_store_dwordx4 v[84:87], v196, s[32:35], s4 offen offset:32
    s_nop 1
L_fin:
    s_endpgm
L_fallback:
    s_nop 4
    v_mov_b32 v152, 0
    v_cndmask_b32 v22, v22, v152, s[60:61]
    v_mov_b32 v157, 0xff800000
    s_lshl_b32 s57, s48, 19
    s_add_u32 s57, s57, 18874368
    s_mov_b32 s56, s57
    s_add_u32 s58, s57, 262144
L_fb1:
    buffer_load_dwordx4 v[160:163], v2, s[28:31], s56 offen sc1
    buffer_load_dwordx4 v[164:167], v2, s[28:31], s56 offen offset:1024 sc1
    s_waitcnt vmcnt(0)
    v_mfma_f32_32x32x16_bf16 v[112:127], v[160:163], v[16:19], 0
    v_mfma_f32_32x32x16_bf16 v[112:127], v[164:167], v[20:23], v[112:127]
    s_nop 11
    v_max3_f32 v157, v157, v112, v113
    v_max3_f32 v157, v157, v114, v115
    v_max3_f32 v157, v157, v116, v117
    v_max3_f32 v157, v157, v118, v119
    v_max3_f32 v157, v157, v120, v121
    v_max3_f32 v157, v157, v122, v123
    v_max3_f32 v157, v157, v124, v125
    v_max3_f32 v157, v157, v126, v127
    s_add_u32 s56, s56, 4096
    s_cmp_lt_u32 s56, s58
    s_cbranch_scc1 L_fb1
    v_mov_b32 v158, v157
    s_nop 1
    v_permlane32_swap_b32 v157, v158
    v_max_f32 v157, v157, v158
    v_mov_b32 v48, 0
    v_mov_b32 v49, 0
    v_mov_b32 v50, 0
    v_mov_b32 v51, 0
    v_mov_b32 v52, 0
    v_mov_b32 v53, 0
    v_mov_b32 v54, 0
    v_mov_b32 v55, 0
    v_mov_b32 v56, 0
    v_mov_b32 v57, 0
    v_mov_b32 v58, 0
    v_mov_b32 v59, 0
    v_mov_b32 v60, 0
    v_mov_b32 v61, 0
    v_mov_b32 v62, 0
    v_mov_b32 v63, 0
    s_mov_b32 s56, s57
    s_nop 0
L_fb2:
    buffer_load_dwordx4 v[160:163], v2, s[28:31], s56 offen offset:0 sc1
    buffer_load_dwordx4 v[164:167], v2, s[28:31], s56 offen offset:1024 sc1
    buffer_load_dwordx4 v[168:171], v2, s[28:31], s56 offen offset:2048 sc1
    buffer_load_dwordx4 v[172:175], v2, s[28:31], s56 offen offset:3072 sc1
    s_waitcnt vmcnt(0)
    v_mfma_f32_32x32x16_bf16 v[112:127], v[160:163], v[16:19], 0
    v_mfma_f32_32x32x16_bf16 v[112:127], v[164:167], v[20:23], v[112:127]
    s_nop 11
    v_sub_f32 v112, v112, v157
    v_sub_f32 v113, v113, v157
    v_sub_f32 v114, v114, v157
    v_sub_f32 v115, v115, v157
    v_sub_f32 v116, v116, v157
    v_sub_f32 v117, v117, v157
    v_sub_f32 v118, v118, v157
    v_sub_f32 v119, v119, v157
    v_sub_f32 v120, v120, v157
    v_sub_f32 v121, v121, v157
    v_sub_f32 v122, v122, v157
    v_sub_f32 v123, v123, v157
    v_sub_f32 v124, v124, v157
    v_sub_f32 v125, v125, v157
    v_sub_f32 v126, v126, v157
    v_sub_f32 v127, v127, v157
    v_exp_f32 v112, v112
    v_exp_f32 v113, v113
    v_exp_f32 v114, v114
    v_exp_f32 v115, v115
    v_exp_f32 v116, v116
    v_exp_f32 v117, v117
    v_exp_f32 v118, v118
    v_exp_f32 v119, v119
    v_exp_f32 v120, v120
    v_exp_f32 v121, v121
    v_exp_f32 v122, v122
    v_exp_f32 v123, v123
    v_exp_f32 v124, v124
    v_exp_f32 v125, v125
    v_exp_f32 v126, v126
    v_exp_f32 v127, v127
    v_cvt_pk_bf16_f32 v144, v112, v113
    v_cvt_pk_bf16_f32 v145, v114, v115
    v_cvt_pk_bf16_f32 v146, v116, v117
    v_cvt_pk_bf16_f32 v147, v118, v119
    v_cvt_pk_bf16_f32 v148, v120, v121
    v_cvt_pk_bf16_f32 v149, v122, v123
    v_cvt_pk_bf16_f32 v150, v124, v125
    v_cvt_pk_bf16_f32 v151, v126, v127
    v_mfma_f32_32x32x16_bf16 v[48:63], v[168:171], v[144:147], v[48:63]
    s_nop 0
    v_mfma_f32_32x32x16_bf16 v[48:63], v[172:175], v[148:151], v[48:63]
    s_add_u32 s56, s56, 4096
    s_cmp_lt_u32 s56, s58
    s_nop 9
    s_cbranch_scc1 L_fb2
    v_mov_b32 v152, v60
    v_mov_b32 v153, v60
    s_nop 1
    v_permlane32_swap_b32 v152, v153
    s_nop 1
    s_branch L_norm_6

L_end:
    s_endpgm
.section .rodata,"a"
.p2align 6
.amdhsa_kernel sequential_preLN__softmax_full_mha__mixer_channel_mlp__prompt_kernel
  .amdhsa_next_free_vgpr 512
  .amdhsa_next_free_sgpr 102
  .amdhsa_accum_offset 256
  .amdhsa_group_segment_fixed_size 0
  .amdhsa_kernarg_size 88
  .amdhsa_user_sgpr_count 2
  .amdhsa_user_sgpr_kernarg_segment_ptr 1
  .amdhsa_system_sgpr_workgroup_id_x 1
.end_amdhsa_kernel
```
